```python
import torch

def _softmax(x, axis=-1):
    return torch.softmax(x, dim=axis)
def _gelu(x):
    return torch.nn.functional.gelu(x, approximate="tanh")
def _silu(x):
    return torch.nn.functional.silu(x)
def _sigmoid(x):
    return torch.sigmoid(x)
def _layernorm(x, axis=-1, eps=1e-5):
    m = x.mean(dim=axis, keepdim=True)
    v = x.var(dim=axis, keepdim=True, unbiased=False)
    return (x - m) / torch.sqrt(v + eps)
def _scatter_add(tgt, idx, src, axis=0):
    return tgt.clone().index_add_(axis, idx, src)
def _segment_sum(src, seg, n):
    out = torch.zeros((n,) + src.shape[1:], dtype=src.dtype)
    return out.index_add_(0, seg, src)
def _pad(x, pw):
    flat = tuple(v for pair in reversed(pw) for v in pair)
    return torch.nn.functional.pad(x, flat)

kernel_name = 'concat_heads__sliding_block__ssm_conv_h3__prompt'

def setup_inputs():

    _w = (lambda a: (lambda t: t.to(torch.bfloat16) if t.is_floating_point() else t)(torch.as_tensor(a)))
    def _A_setup():
        B, S, D = 1, 2048, 576
        return {
            "x": _w((lambda *s: torch.randn(*s, dtype=torch.bfloat16) * 0.2)(B, S, D)),
            "wqkv": _w((lambda *s: torch.randn(*s, dtype=torch.bfloat16) * 0.2)(D, 3 * D)),
            "wo": _w((lambda *s: torch.randn(*s, dtype=torch.bfloat16) * 0.05)(D, D)),
        }
    _A_in = _A_setup()

    def _B_setup():
        B, S, D = 1, 2048, 576
        ks = 4
        return {
            "q": _w((lambda *s: torch.randn(*s, dtype=torch.bfloat16) * 0.05)(B, S, D)),
            "k": _w((lambda *s: torch.randn(*s, dtype=torch.bfloat16) * 0.8)(B, S, D)),
            "v": _w((lambda *s: torch.randn(*s, dtype=torch.bfloat16) * 0.8)(B, S, D)),
            "shift_k": _w((lambda *s: torch.randn(*s, dtype=torch.bfloat16) * 0.8)(D, ks) * 0.5),
            "ssm_k": _w((lambda *s: torch.randn(*s, dtype=torch.bfloat16) * 3.2)(D, S) * (1.0 / S ** 0.5)),
            "ssm_D": _w((lambda *s: torch.randn(*s, dtype=torch.bfloat16) * 0.8)(D)),
        }
    _B_in = _B_setup()

    return {
        "A_x": _A_in["x"],
        "A_wqkv": _A_in["wqkv"],
        "A_wo": _A_in["wo"],
        "B_q": _B_in["q"],
        "B_k": _B_in["k"],
        "B_v": _B_in["v"],
        "B_shift_k": _B_in["shift_k"],
        "B_ssm_k": _B_in["ssm_k"],
        "B_ssm_D": _B_in["ssm_D"],
    }

def reference(A_x, A_wqkv, A_wo, B_q, B_k, B_v, B_shift_k, B_ssm_k, B_ssm_D):
    def _A_ref(x, wqkv, wo):
        B, S, D = x.shape
        H = 32; Dh = D // H; W = 256
        qkv = (lambda x, *d: x.permute(*d))((x @ wqkv).reshape(B, S, 3, H, Dh), 2, 0, 3, 1, 4)
        q, k, v = qkv[0], qkv[1], qkv[2]
        scores = torch.einsum("bhqd,bhkd->bhqk", q, k) * (Dh ** -0.5)
        idx = torch.arange(S)
        mask = (idx[:, None] - idx[None, :] >= 0) & (idx[:, None] - idx[None, :] < W)
        scores = torch.where(mask[None, None], scores, -1e9)
        p = _softmax(scores, axis=-1)
        o = torch.einsum("bhqk,bhkd->bhqd", p, v)
        return (lambda x, *d: x.permute(*d))(o, 0, 2, 1, 3).reshape(B, S, D) @ wo

    def _B_ref(q, k, v, shift_k, ssm_k, ssm_D):
        B, S, D = q.shape
        ks = shift_k.shape[-1]
        k_pad = _pad(k, ((0, 0), (ks - 1, 0), (0, 0)))
        k_shift = torch.zeros_like(k)
        for t in range(ks):
            k_shift = k_shift + k_pad[:, t:t + S, :] * shift_k[:, ks - 1 - t][None, None, :]
        kv = k_shift * v
        L = 2 * S
        kv_pad = _pad(kv, ((0, 0), (0, S), (0, 0)))
        kf_pad = _pad(ssm_k, ((0, 0), (0, S)))
        kv_f = (lambda x, axes=(-2,-1): torch.fft.rfft2(x.float(), dim=axes))(kv_pad[:, None, :, :], axes=(1, 2))
        kf_f = (lambda x, axes=(-2,-1): torch.fft.rfft2(x.float(), dim=axes))(kf_pad[:, None, :], axes=(1, 2))
        kf_f = (lambda x, *d: x.permute(*d))(kf_f, 1, 2, 0)
        y_f = kv_f * kf_f[None, :, :, :]
        y = (lambda x, s, axes=(-2,-1): torch.fft.irfft2(x, s=s, dim=axes).to(torch.bfloat16))(y_f, (1, L), axes=(1, 2))[:, 0, :S, :]
        y = y + kv * ssm_D[None, None, :]
        return q * y

    a = _A_ref(A_x, A_wqkv, A_wo)
    b = _B_ref(B_q, B_k, B_v, B_shift_k, B_ssm_k, B_ssm_D)
    return torch.concatenate([a, b], axis=-1)
```

```asm
; @launch grid=(256,1,1) block=(512,1,1) lds=163840
.amdgcn_target "amdgcn-amd-amdhsa--gfx950"
.text
.globl concat_heads__sliding_block__ssm_conv_h3__prompt_kernel
.p2align 8
.type concat_heads__sliding_block__ssm_conv_h3__prompt_kernel,@function
concat_heads__sliding_block__ssm_conv_h3__prompt_kernel:
    s_load_dwordx16 s[16:31], s[0:1], 0
    s_load_dwordx8 s[32:39], s[0:1], 64
    v_and_b32 v1, 63, v0
    v_lshrrev_b32 v13, 6, v0
    s_nop 0
    v_readfirstlane_b32 s15, v13
    s_cmp_ge_u32 s2, 256
    s_cbranch_scc1 M_EXIT
    s_and_b32 s3, s15, 3
    s_cmp_ge_u32 s2, 192
    s_cbranch_scc1 M_S1
    s_and_b32 s12, s2, 7
    s_lshr_b32 s13, s2, 3
    s_and_b32 s60, s13, 3
    s_lshr_b32 s61, s13, 2
    s_lshr_b32 s14, s12, 1
    s_lshl_b32 s14, s14, 2
    s_add_u32 s14, s14, s60
    s_lshl_b32 s6, s14, 2
    s_add_u32 s6, s6, s3
    s_and_b32 s14, s12, 1
    s_mul_i32 s14, s14, 6
    s_add_u32 s14, s14, s61
    s_lshr_b32 s4, s14, 2
    s_and_b32 s5, s14, 3
    s_mul_i32 s7, s14, 288
    s_cmp_lt_u32 s15, 4
    s_cbranch_scc1 M_GC
    s_mul_i32 s8, s3, 4608
    s_lshl_b32 s12, s3, 12
    s_add_u32 s12, s12, 18432
    s_mov_b32 s10, -1
    s_mov_b32 s11, 0
    v_lshrrev_b32 v16, 3, v1
    v_lshrrev_b32 v17, 2, v16
    v_lshlrev_b32 v17, 3, v17
    v_and_b32 v18, 3, v16
    v_add_u32 v17, v17, v18
    s_lshl_b32 s14, s6, 5
    v_add_u32 v17, s14, v17
    v_mul_u32_u24 v17, 1152, v17
    v_lshrrev_b32 v18, 4, v1
    v_xor_b32 v18, v18, v1
    v_and_b32 v18, 7, v18
    v_xor_b32 v19, 4, v18
    v_lshl_add_u32 v18, v18, 4, v17
    v_lshl_add_u32 v19, v19, 4, v17
    v_add_u32 v9, 0, v18
    v_add_u32 v10, 17408, v19
    v_add_u32 v11, 2560, v18
    v_add_u32 v12, 19968, v19
    s_mul_i32 s62, s60, 9
    s_add_u32 s62, s62, 1
    s_lshr_b32 s62, s62, 2
    s_mul_i32 s63, s61, 3
    s_add_u32 s63, s63, 1
    s_lshr_b32 s63, s63, 1
    s_add_u32 s62, s62, s63
    s_sub_u32 s63, s62, 9
    s_cmp_ge_u32 s62, 9
    s_cselect_b32 s62, s63, s62
    s_waitcnt lgkmcnt(0)
    s_mov_b32 s44, s16
    s_mov_b32 s45, s17
    s_mov_b32 s46, 2359296
    s_mov_b32 s47, 0x00020000
    s_mov_b32 s48, s18
    s_mov_b32 s49, s19
    s_mov_b32 s50, 1990656
    s_mov_b32 s51, 0x00020000
    s_mov_b32 s40, s38
    s_mov_b32 s41, s39
    s_mov_b32 s42, 17432576
    s_mov_b32 s43, 0x00020000
    s_mov_b32 s63, s62
    s_add_u32 m0, s12, 0
    s_lshl_b32 s9, s63, 7
    buffer_load_dwordx4 v9, s[44:47], s9 offen offset:0 lds
    buffer_load_dwordx4 v10, s[44:47], s9 offen offset:1024 lds
    buffer_load_dwordx4 v11, s[44:47], s9 offen offset:2048 lds
    buffer_load_dwordx4 v12, s[44:47], s9 offen offset:3072 lds
    s_add_u32 s63, s63, 1
    s_cmp_eq_u32 s63, 9
    s_cselect_b32 s63, 0, s63
    s_lshl_b32 s14, s3, 4
    v_add_u32 v16, 0, v1
    v_mul_u32_u24 v17, 57, v16
    v_lshrrev_b32 v17, 10, v17
    v_mul_u32_u24 v18, 18, v17
    v_sub_u32 v18, v16, v18
    v_and_b32 v19, 3, v17
    v_and_b32 v20, 4, v17
    v_lshl_or_b32 v19, v20, 1, v19
    v_and_b32 v20, 8, v17
    v_lshrrev_b32 v20, 1, v20
    v_or_b32 v19, v19, v20
    v_add_u32 v19, s14, v19
    v_mul_u32_u24 v19, 3456, v19
    v_lshl_add_u32 v19, v18, 4, v19
    v_add_u32 v4, s7, v19
    v_add_u32 v16, 64, v1
    v_mul_u32_u24 v17, 57, v16
    v_lshrrev_b32 v17, 10, v17
    v_mul_u32_u24 v18, 18, v17
    v_sub_u32 v18, v16, v18
    v_and_b32 v19, 3, v17
    v_and_b32 v20, 4, v17
    v_lshl_or_b32 v19, v20, 1, v19
    v_and_b32 v20, 8, v17
    v_lshrrev_b32 v20, 1, v20
    v_or_b32 v19, v19, v20
    v_add_u32 v19, s14, v19
    v_mul_u32_u24 v19, 3456, v19
    v_lshl_add_u32 v19, v18, 4, v19
    v_add_u32 v5, s7, v19
    v_subrev_u32 v5, 1024, v5
    v_add_u32 v16, 128, v1
    v_mul_u32_u24 v17, 57, v16
    v_lshrrev_b32 v17, 10, v17
    v_mul_u32_u24 v18, 18, v17
    v_sub_u32 v18, v16, v18
    v_and_b32 v19, 3, v17
    v_and_b32 v20, 4, v17
    v_lshl_or_b32 v19, v20, 1, v19
    v_and_b32 v20, 8, v17
    v_lshrrev_b32 v20, 1, v20
    v_or_b32 v19, v19, v20
    v_add_u32 v19, s14, v19
    v_mul_u32_u24 v19, 3456, v19
    v_lshl_add_u32 v19, v18, 4, v19
    v_add_u32 v6, s7, v19
    v_subrev_u32 v6, 2048, v6
    v_add_u32 v16, 192, v1
    v_mul_u32_u24 v17, 57, v16
    v_lshrrev_b32 v17, 10, v17
    v_mul_u32_u24 v18, 18, v17
    v_sub_u32 v18, v16, v18
    v_and_b32 v19, 3, v17
    v_and_b32 v20, 4, v17
    v_lshl_or_b32 v19, v20, 1, v19
    v_and_b32 v20, 8, v17
    v_lshrrev_b32 v20, 1, v20
    v_or_b32 v19, v19, v20
    v_add_u32 v19, s14, v19
    v_mul_u32_u24 v19, 3456, v19
    v_lshl_add_u32 v19, v18, 4, v19
    v_add_u32 v7, s7, v19
    v_subrev_u32 v7, 3072, v7
    v_add_u32 v16, 256, v1
    v_mul_u32_u24 v17, 57, v16
    v_lshrrev_b32 v17, 10, v17
    v_mul_u32_u24 v18, 18, v17
    v_sub_u32 v18, v16, v18
    v_and_b32 v19, 3, v17
    v_and_b32 v20, 4, v17
    v_lshl_or_b32 v19, v20, 1, v19
    v_and_b32 v20, 8, v17
    v_lshrrev_b32 v20, 1, v20
    v_or_b32 v19, v19, v20
    v_add_u32 v19, s14, v19
    v_mul_u32_u24 v19, 3456, v19
    v_lshl_add_u32 v19, v18, 4, v19
    v_add_u32 v8, s7, v19
    s_add_u32 m0, s8, 0
    s_mul_i32 s9, s62, 221184
    buffer_load_dwordx4 v4, s[48:51], s9 offen offset:0 lds
    buffer_load_dwordx4 v5, s[48:51], s9 offen offset:1024 lds
    buffer_load_dwordx4 v6, s[48:51], s9 offen offset:2048 lds
    buffer_load_dwordx4 v7, s[48:51], s9 offen offset:3072 lds
    s_add_u32 m0, s8, 4096
    s_mov_b64 exec, s[10:11]
    buffer_load_dwordx4 v8, s[48:51], s9 offen lds
    s_mov_b64 exec, -1
    s_add_u32 s62, s62, 1
    s_cmp_eq_u32 s62, 9
    s_cselect_b32 s62, 0, s62
    s_add_u32 m0, s12, 34816
    s_lshl_b32 s9, s63, 7
    buffer_load_dwordx4 v9, s[44:47], s9 offen offset:0 lds
    buffer_load_dwordx4 v10, s[44:47], s9 offen offset:1024 lds
    buffer_load_dwordx4 v11, s[44:47], s9 offen offset:2048 lds
    buffer_load_dwordx4 v12, s[44:47], s9 offen offset:3072 lds
    s_add_u32 s63, s63, 1
    s_cmp_eq_u32 s63, 9
    s_cselect_b32 s63, 0, s63
    s_add_u32 m0, s8, 34816
    s_mul_i32 s9, s62, 221184
    buffer_load_dwordx4 v4, s[48:51], s9 offen offset:0 lds
    buffer_load_dwordx4 v5, s[48:51], s9 offen offset:1024 lds
    buffer_load_dwordx4 v6, s[48:51], s9 offen offset:2048 lds
    buffer_load_dwordx4 v7, s[48:51], s9 offen offset:3072 lds
    s_add_u32 m0, s8, 38912
    s_mov_b64 exec, s[10:11]
    buffer_load_dwordx4 v8, s[48:51], s9 offen lds
    s_mov_b64 exec, -1
    s_add_u32 s62, s62, 1
    s_cmp_eq_u32 s62, 9
    s_cselect_b32 s62, 0, s62
    s_getpc_b64 s[58:59]
LPC1:
    s_add_u32 s58, s58, M_TAB-LPC1
    s_addc_u32 s59, s59, 0
    s_load_dwordx16 s[64:79], s[58:59], 0
    s_load_dwordx16 s[80:95], s[58:59], 64
    v_lshlrev_b32 v251, 4, v1
    global_load_dwordx4 v[228:231], v251, s[58:59] offset:128
    global_load_dwordx4 v[232:235], v251, s[58:59] offset:1152
    global_load_dwordx4 v[240:243], v251, s[58:59] offset:2176
    global_load_dwordx4 v[244:247], v251, s[58:59] offset:3200
    s_waitcnt vmcnt(13)
    s_barrier
    s_add_u32 m0, s12, 69632
    s_lshl_b32 s9, s63, 7
    buffer_load_dwordx4 v9, s[44:47], s9 offen offset:0 lds
    buffer_load_dwordx4 v10, s[44:47], s9 offen offset:1024 lds
    buffer_load_dwordx4 v11, s[44:47], s9 offen offset:2048 lds
    buffer_load_dwordx4 v12, s[44:47], s9 offen offset:3072 lds
    s_add_u32 s63, s63, 1
    s_cmp_eq_u32 s63, 9
    s_cselect_b32 s63, 0, s63
    s_add_u32 m0, s8, 69632
    s_mul_i32 s9, s62, 221184
    buffer_load_dwordx4 v4, s[48:51], s9 offen offset:0 lds
    buffer_load_dwordx4 v5, s[48:51], s9 offen offset:1024 lds
    buffer_load_dwordx4 v6, s[48:51], s9 offen offset:2048 lds
    buffer_load_dwordx4 v7, s[48:51], s9 offen offset:3072 lds
    s_add_u32 m0, s8, 73728
    s_mov_b64 exec, s[10:11]
    buffer_load_dwordx4 v8, s[48:51], s9 offen lds
    s_mov_b64 exec, -1
    s_add_u32 s62, s62, 1
    s_cmp_eq_u32 s62, 9
    s_cselect_b32 s62, 0, s62
    s_waitcnt vmcnt(13)
    s_barrier
    s_add_u32 m0, s12, 104448
    s_lshl_b32 s9, s63, 7
    buffer_load_dwordx4 v9, s[44:47], s9 offen offset:0 lds
    buffer_load_dwordx4 v10, s[44:47], s9 offen offset:1024 lds
    buffer_load_dwordx4 v11, s[44:47], s9 offen offset:2048 lds
    buffer_load_dwordx4 v12, s[44:47], s9 offen offset:3072 lds
    s_add_u32 s63, s63, 1
    s_cmp_eq_u32 s63, 9
    s_cselect_b32 s63, 0, s63
    s_add_u32 m0, s8, 104448
    s_mul_i32 s9, s62, 221184
    buffer_load_dwordx4 v4, s[48:51], s9 offen offset:0 lds
    buffer_load_dwordx4 v5, s[48:51], s9 offen offset:1024 lds
    buffer_load_dwordx4 v6, s[48:51], s9 offen offset:2048 lds
    buffer_load_dwordx4 v7, s[48:51], s9 offen offset:3072 lds
    s_add_u32 m0, s8, 108544
    s_mov_b64 exec, s[10:11]
    buffer_load_dwordx4 v8, s[48:51], s9 offen lds
    s_mov_b64 exec, -1
    s_add_u32 s62, s62, 1
    s_cmp_eq_u32 s62, 9
    s_cselect_b32 s62, 0, s62
    s_waitcnt vmcnt(9)
    s_barrier
    s_add_u32 m0, s12, 0
    s_lshl_b32 s9, s63, 7
    buffer_load_dwordx4 v9, s[44:47], s9 offen offset:0 lds
    buffer_load_dwordx4 v10, s[44:47], s9 offen offset:1024 lds
    buffer_load_dwordx4 v11, s[44:47], s9 offen offset:2048 lds
    buffer_load_dwordx4 v12, s[44:47], s9 offen offset:3072 lds
    s_add_u32 s63, s63, 1
    s_cmp_eq_u32 s63, 9
    s_cselect_b32 s63, 0, s63
    s_add_u32 m0, s8, 0
    s_mul_i32 s9, s62, 221184
    buffer_load_dwordx4 v4, s[48:51], s9 offen offset:0 lds
    buffer_load_dwordx4 v5, s[48:51], s9 offen offset:1024 lds
    buffer_load_dwordx4 v6, s[48:51], s9 offen offset:2048 lds
    buffer_load_dwordx4 v7, s[48:51], s9 offen offset:3072 lds
    s_add_u32 m0, s8, 4096
    s_mov_b64 exec, s[10:11]
    buffer_load_dwordx4 v8, s[48:51], s9 offen lds
    s_mov_b64 exec, -1
    s_add_u32 s62, s62, 1
    s_cmp_eq_u32 s62, 9
    s_cselect_b32 s62, 0, s62
    s_waitcnt vmcnt(9)
    s_barrier
    s_add_u32 m0, s12, 34816
    s_lshl_b32 s9, s63, 7
    buffer_load_dwordx4 v9, s[44:47], s9 offen offset:0 lds
    buffer_load_dwordx4 v10, s[44:47], s9 offen offset:1024 lds
    buffer_load_dwordx4 v11, s[44:47], s9 offen offset:2048 lds
    buffer_load_dwordx4 v12, s[44:47], s9 offen offset:3072 lds
    s_add_u32 s63, s63, 1
    s_cmp_eq_u32 s63, 9
    s_cselect_b32 s63, 0, s63
    s_add_u32 m0, s8, 34816
    s_mul_i32 s9, s62, 221184
    buffer_load_dwordx4 v4, s[48:51], s9 offen offset:0 lds
    buffer_load_dwordx4 v5, s[48:51], s9 offen offset:1024 lds
    buffer_load_dwordx4 v6, s[48:51], s9 offen offset:2048 lds
    buffer_load_dwordx4 v7, s[48:51], s9 offen offset:3072 lds
    s_add_u32 m0, s8, 38912
    s_mov_b64 exec, s[10:11]
    buffer_load_dwordx4 v8, s[48:51], s9 offen lds
    s_mov_b64 exec, -1
    s_add_u32 s62, s62, 1
    s_cmp_eq_u32 s62, 9
    s_cselect_b32 s62, 0, s62
    s_mov_b32 s52, s36
    s_mov_b32 s53, s37
    s_mov_b32 s54, 256
    s_mov_b32 s55, 0x00020000
    v_mov_b32 v238, 0
    buffer_load_dwordx2 v[236:237], v238, s[52:55], 0 offen sc1
    s_waitcnt vmcnt(10)
    s_barrier
    s_add_u32 m0, s12, 69632
    s_lshl_b32 s9, s63, 7
    buffer_load_dwordx4 v9, s[44:47], s9 offen offset:0 lds
    buffer_load_dwordx4 v10, s[44:47], s9 offen offset:1024 lds
    buffer_load_dwordx4 v11, s[44:47], s9 offen offset:2048 lds
    buffer_load_dwordx4 v12, s[44:47], s9 offen offset:3072 lds
    s_add_u32 s63, s63, 1
    s_cmp_eq_u32 s63, 9
    s_cselect_b32 s63, 0, s63
    s_add_u32 m0, s8, 69632
    s_mul_i32 s9, s62, 221184
    buffer_load_dwordx4 v4, s[48:51], s9 offen offset:0 lds
    buffer_load_dwordx4 v5, s[48:51], s9 offen offset:1024 lds
    buffer_load_dwordx4 v6, s[48:51], s9 offen offset:2048 lds
    buffer_load_dwordx4 v7, s[48:51], s9 offen offset:3072 lds
    s_add_u32 m0, s8, 73728
    s_mov_b64 exec, s[10:11]
    buffer_load_dwordx4 v8, s[48:51], s9 offen lds
    s_mov_b64 exec, -1
    s_add_u32 s62, s62, 1
    s_cmp_eq_u32 s62, 9
    s_cselect_b32 s62, 0, s62
    s_waitcnt vmcnt(10)
    s_barrier
    s_add_u32 m0, s12, 104448
    s_lshl_b32 s9, s63, 7
    buffer_load_dwordx4 v9, s[44:47], s9 offen offset:0 lds
    buffer_load_dwordx4 v10, s[44:47], s9 offen offset:1024 lds
    buffer_load_dwordx4 v11, s[44:47], s9 offen offset:2048 lds
    buffer_load_dwordx4 v12, s[44:47], s9 offen offset:3072 lds
    s_add_u32 s63, s63, 1
    s_cmp_eq_u32 s63, 9
    s_cselect_b32 s63, 0, s63
    s_add_u32 m0, s8, 104448
    s_mul_i32 s9, s62, 221184
    buffer_load_dwordx4 v4, s[48:51], s9 offen offset:0 lds
    buffer_load_dwordx4 v5, s[48:51], s9 offen offset:1024 lds
    buffer_load_dwordx4 v6, s[48:51], s9 offen offset:2048 lds
    buffer_load_dwordx4 v7, s[48:51], s9 offen offset:3072 lds
    s_add_u32 m0, s8, 108544
    s_mov_b64 exec, s[10:11]
    buffer_load_dwordx4 v8, s[48:51], s9 offen lds
    s_mov_b64 exec, -1
    s_add_u32 s62, s62, 1
    s_cmp_eq_u32 s62, 9
    s_cselect_b32 s62, 0, s62
    s_lshr_b32 s29, s3, 1
    s_lshl_b32 s28, s2, 1
    s_add_u32 s28, s28, s29
    s_add_u32 s28, s28, 192
    s_add_u32 s29, s29, 1
    s_lshr_b32 s26, s28, 6
    s_lshl_b32 s26, s26, 12
    s_add_u32 s26, s26, 16809984
    v_lshl_add_u32 v120, v1, 7, s26
    s_lshl_b32 s14, s3, 10
    s_waitcnt vmcnt(9)
    s_barrier
    s_add_u32 m0, s12, 0
    s_lshl_b32 s9, s63, 7
    buffer_load_dwordx4 v9, s[44:47], s9 offen offset:0 lds
    buffer_load_dwordx4 v10, s[44:47], s9 offen offset:1024 lds
    buffer_load_dwordx4 v11, s[44:47], s9 offen offset:2048 lds
    buffer_load_dwordx4 v12, s[44:47], s9 offen offset:3072 lds
    s_add_u32 s63, s63, 1
    s_cmp_eq_u32 s63, 9
    s_cselect_b32 s63, 0, s63
    s_add_u32 m0, s8, 0
    s_mul_i32 s9, s62, 221184
    buffer_load_dwordx4 v4, s[48:51], s9 offen offset:0 lds
    buffer_load_dwordx4 v5, s[48:51], s9 offen offset:1024 lds
    buffer_load_dwordx4 v6, s[48:51], s9 offen offset:2048 lds
    buffer_load_dwordx4 v7, s[48:51], s9 offen offset:3072 lds
    s_add_u32 m0, s8, 4096
    s_mov_b64 exec, s[10:11]
    buffer_load_dwordx4 v8, s[48:51], s9 offen lds
    s_mov_b64 exec, -1
    s_add_u32 s62, s62, 1
    s_cmp_eq_u32 s62, 9
    s_cselect_b32 s62, 0, s62
    v_lshlrev_b32 v16, 7, v1
    s_mov_b32 s44, s30
    s_mov_b32 s45, s31
    s_mov_b32 s46, 2359296
    s_mov_b32 s47, 0x00020000
    s_lshl_b32 s9, s2, 13
    s_lshl_b32 s13, s3, 11
    s_add_u32 s9, s9, s13
    s_add_u32 s9, s9, 0xC0000
    s_mov_b64 exec, 0xffff
    buffer_load_dword v252, v16, s[44:47], s9 offen
    s_mov_b64 exec, -1
    v_readfirstlane_b32 s56, v236
    v_readfirstlane_b32 s57, v237
    s_nop 0
    s_cmp_lg_u64 s[56:57], 0
    s_cbranch_scc1 TF1
    s_mov_b32 s52, s36
    s_mov_b32 s53, s37
    s_mov_b32 s54, 256
    s_mov_b32 s55, 0x00020000
    v_mov_b32 v238, 0
    s_mov_b32 s58, 0
GT2:
    buffer_load_dwordx2 v[236:237], v238, s[52:55], 0 offen sc1
    s_add_u32 s58, s58, 1
    s_waitcnt vmcnt(0)
    v_readfirstlane_b32 s56, v236
    v_readfirstlane_b32 s57, v237
    s_nop 0
    s_cmp_lg_u64 s[56:57], 0
    s_cbranch_scc1 GD3
    s_cmp_lt_u32 s58, 200000
    s_cbranch_scc1 GT2
GD3:
TF1:
    s_and_b32 s16, s15, 1
    v_lshlrev_b32 v118, 4, v1
    s_lshl_b32 s18, s28, 12
    s_add_u32 s26, s18, 10485760
    s_add_u32 s48, s38, s26
    s_addc_u32 s49, s39, 0
    s_mov_b32 s50, 4096
    s_mov_b32 s51, 0x00020000
    s_lshl_b32 s27, s16, 11
    s_mul_i32 s29, s29, 25792
    s_add_u32 s29, s29, 9024
    v_and_b32 v130, 15, v1
    v_lshrrev_b32 v131, 4, v1
    s_sub_u32 s19, 2359296, s18
    s_add_u32 s52, s30, s18
    s_addc_u32 s53, s31, 0
    s_mov_b32 s54, s19
    s_mov_b32 s55, 0x00020000
    s_mul_i32 s24, s16, 4224
    s_add_u32 s24, s24, s29
    s_lshl_b32 s25, s16, 2
    s_add_u32 s25, s25, 4
    s_sub_u32 s26, s16, 15
    v_add_u32 v119, s26, v130
    v_cmp_eq_u32 s[98:99], 0, v119
    v_lshlrev_b32 v119, 2, v119
    s_add_u32 m0, s24, 64
    s_waitcnt vmcnt(10)
    s_barrier
    s_mov_b32 s10, 2
    s_waitcnt vmcnt(1)
    s_barrier
    s_branch MC_H
M_GC:
    s_lshl_b32 s63, s14, 4
    s_lshr_b32 s62, s6, 2
    s_add_u32 s63, s63, s62
    s_lshl_b32 s63, s63, 7
    s_add_u32 s63, s63, 16777216
    v_and_b32 v14, 15, v1
    v_lshrrev_b32 v15, 4, v1
    v_lshrrev_b32 v16, 1, v14
    v_xor_b32 v16, v16, v15
    v_lshlrev_b32 v16, 4, v16
    v_lshl_add_u32 v16, v14, 7, v16
    s_lshl_b32 s12, s3, 12
    s_add_u32 s12, s12, 18432
    v_add_u32 v4, s12, v16
    v_xor_b32 v5, 64, v4
    v_add_u32 v8, 69632, v4
    v_add_u32 v9, 69632, v5
    v_lshrrev_b32 v16, 1, v15
    v_lshlrev_b32 v16, 4, v16
    v_and_b32 v17, 1, v15
    v_lshl_add_u32 v16, v17, 2, v16
    v_lshrrev_b32 v17, 2, v14
    v_add_u32 v16, v16, v17
    v_mul_u32_u24 v16, 288, v16
    v_and_b32 v17, 3, v14
    s_waitcnt lgkmcnt(0)
    s_mov_b32 s40, s38
    s_mov_b32 s41, s39
    s_mov_b32 s42, 17432576
    s_mov_b32 s43, 0x00020000
    s_mov_b32 s52, s36
    s_mov_b32 s53, s37
    s_mov_b32 s54, 256
    s_mov_b32 s55, 0x00020000
    v_mov_b32 v238, 0
    s_xor_b32 s58, s15, 0
    s_or_b32 s58, s2, s58
    s_cmp_lg_u32 s58, 0
    s_cbranch_scc1 NT4
    s_memrealtime s[58:59]
    s_mov_b32 s52, s36
    s_mov_b32 s53, s37
    s_mov_b32 s54, 256
    s_mov_b32 s55, 0x00020000
    v_mov_b32 v238, 0
    s_waitcnt lgkmcnt(0)
    s_or_b32 s58, s58, 1
    v_mov_b32 v236, s58
    v_mov_b32 v237, s59
    s_mov_b64 exec, 1
    buffer_store_dwordx2 v[236:237], v238, s[52:55], 0 offen sc1
    s_mov_b64 exec, -1
NT4:
    s_getpc_b64 s[58:59]
LPC2:
    s_add_u32 s58, s58, M_TAB-LPC2
    s_addc_u32 s59, s59, 0
    s_load_dwordx16 s[64:79], s[58:59], 0
    s_load_dwordx16 s[80:95], s[58:59], 64
    v_lshlrev_b32 v251, 4, v1
    global_load_dwordx4 v[228:231], v251, s[58:59] offset:128
    global_load_dwordx4 v[232:235], v251, s[58:59] offset:1152
    global_load_dwordx4 v[240:243], v251, s[58:59] offset:2176
    global_load_dwordx4 v[244:247], v251, s[58:59] offset:3200
    s_waitcnt lgkmcnt(0)
    s_mov_b64 exec, 1
    buffer_load_dword v252, v238, s[40:43], s63 offen
    s_mov_b64 exec, -1
    s_cmp_eq_u32 s4, 2
    s_cbranch_scc1 GC_V
    v_lshrrev_b32 v18, 1, v17
    v_mul_u32_u24 v18, 40, v18
    v_and_b32 v19, 1, v17
    v_lshl_add_u32 v18, v19, 4, v18
    v_add_u32 v2, v16, v18
    v_mul_u32_u24 v18, 72, v17
    v_add_u32 v3, v16, v18
    v_add_u32 v6, 69632, v2
    v_add_u32 v7, 69632, v3
    s_cmp_eq_u32 s4, 0
    s_cselect_b32 s13, 0, 2621440
    s_mov_b32 s10, 2359296
    s_cselect_b32 s10, 2097152, s10
    s_lshl_b32 s9, s5, 9
    s_add_u32 s9, s9, s6
    s_lshl_b32 s9, s9, 10
    s_add_u32 s13, s13, s9
    s_mov_b32 s12, 65536
    v_and_b32 v16, 7, v14
    v_lshrrev_b32 v17, 3, v14
    v_lshl_add_u32 v16, v17, 4, v16
    v_lshrrev_b32 v17, 1, v15
    v_mul_lo_u32 v17, v17, s12
    v_and_b32 v18, 1, v15
    v_lshl_add_u32 v17, v18, 9, v17
    v_lshl_add_u32 v17, v16, 4, v17
    v_add_u32 v10, s13, v17
    s_lshl_b32 s9, s5, 8
    s_add_u32 s9, s9, s6
    s_lshl_b32 s9, s9, 8
    s_add_u32 s10, s10, s9
    v_lshlrev_b32 v17, 14, v15
    v_lshl_add_u32 v17, v14, 4, v17
    v_add_u32 v11, s10, v17
    s_lshl_b32 s9, s12, 1
    s_getpc_b64 s[58:59]
    s_lshl_b32 s60, s3, 4
    v_add_u32 v12, s60, v1
    v_lshlrev_b32 v12, 7, v12
    s_mov_b32 exec_lo, 0xffff
    s_mov_b32 exec_hi, 0
    global_load_dword v13, v12, s[58:59]
    s_mov_b64 exec, -1
    s_barrier
    ds_read_b128 v[16:19], v4 offset:0
    ds_read_b128 v[20:23], v4 offset:2048
    ds_read_b64_tr_b16 v[32:33], v2 offset:0
    ds_read_b64_tr_b16 v[34:35], v2 offset:2304
    ds_read_b64_tr_b16 v[36:37], v2 offset:8
    ds_read_b64_tr_b16 v[38:39], v2 offset:2312
    ds_read_b64_tr_b16 v[40:41], v2 offset:72
    ds_read_b64_tr_b16 v[42:43], v2 offset:2376
    ds_read_b64_tr_b16 v[44:45], v2 offset:80
    ds_read_b64_tr_b16 v[46:47], v2 offset:2384
    ds_read_b64_tr_b16 v[48:49], v2 offset:144
    ds_read_b64_tr_b16 v[50:51], v2 offset:2448
    ds_read_b64_tr_b16 v[52:53], v2 offset:152
    ds_read_b64_tr_b16 v[54:55], v2 offset:2456
    s_waitcnt lgkmcnt(10)
    v_mfma_f32_16x16x32_bf16 v[68:71], v[32:35], v[16:19], 0
    ds_read_b64_tr_b16 v[56:57], v2 offset:216
    v_mfma_f32_16x16x32_bf16 v[72:75], v[32:35], v[20:23], 0
    ds_read_b64_tr_b16 v[58:59], v2 offset:2520
    s_waitcnt lgkmcnt(10)
    v_mfma_f32_16x16x32_bf16 v[76:79], v[36:39], v[16:19], 0
    ds_read_b64_tr_b16 v[60:61], v2 offset:224
    v_mfma_f32_16x16x32_bf16 v[80:83], v[36:39], v[20:23], 0
    ds_read_b64_tr_b16 v[62:63], v2 offset:2528
    s_waitcnt lgkmcnt(10)
    v_mfma_f32_16x16x32_bf16 v[84:87], v[40:43], v[16:19], 0
    ds_read_b64_tr_b16 v[64:65], v3 offset:32
    v_mfma_f32_16x16x32_bf16 v[88:91], v[40:43], v[20:23], 0
    ds_read_b64_tr_b16 v[66:67], v3 offset:2336
    s_waitcnt lgkmcnt(10)
    v_mfma_f32_16x16x32_bf16 v[92:95], v[44:47], v[16:19], 0
    ds_read_b128 v[24:27], v5 offset:0
    ds_read_b128 v[28:31], v5 offset:2048
    v_mfma_f32_16x16x32_bf16 v[96:99], v[44:47], v[20:23], 0
    ds_read_b64_tr_b16 v[32:33], v2 offset:9216
    ds_read_b64_tr_b16 v[34:35], v2 offset:11520
    s_waitcnt lgkmcnt(12)
    v_mfma_f32_16x16x32_bf16 v[100:103], v[48:51], v[16:19], 0
    ds_read_b64_tr_b16 v[36:37], v2 offset:9224
    v_mfma_f32_16x16x32_bf16 v[104:107], v[48:51], v[20:23], 0
    ds_read_b64_tr_b16 v[38:39], v2 offset:11528
    s_waitcnt lgkmcnt(12)
    v_mfma_f32_16x16x32_bf16 v[108:111], v[52:55], v[16:19], 0
    ds_read_b64_tr_b16 v[40:41], v2 offset:9288
    v_mfma_f32_16x16x32_bf16 v[112:115], v[52:55], v[20:23], 0
    ds_read_b64_tr_b16 v[42:43], v2 offset:11592
    s_waitcnt lgkmcnt(12)
    v_mfma_f32_16x16x32_bf16 v[116:119], v[56:59], v[16:19], 0
    ds_read_b64_tr_b16 v[44:45], v2 offset:9296
    v_mfma_f32_16x16x32_bf16 v[120:123], v[56:59], v[20:23], 0
    ds_read_b64_tr_b16 v[46:47], v2 offset:11600
    s_waitcnt lgkmcnt(12)
    v_mfma_f32_16x16x32_bf16 v[124:127], v[60:63], v[16:19], 0
    ds_read_b64_tr_b16 v[48:49], v2 offset:9360
    v_mfma_f32_16x16x32_bf16 v[128:131], v[60:63], v[20:23], 0
    ds_read_b64_tr_b16 v[50:51], v2 offset:11664
    s_waitcnt lgkmcnt(12)
    v_mfma_f32_16x16x32_bf16 v[132:135], v[64:67], v[16:19], 0
    ds_read_b64_tr_b16 v[52:53], v2 offset:9368
    v_mfma_f32_16x16x32_bf16 v[136:139], v[64:67], v[20:23], 0
    ds_read_b64_tr_b16 v[54:55], v2 offset:11672
    s_waitcnt lgkmcnt(10)
    v_mfma_f32_16x16x32_bf16 v[68:71], v[32:35], v[24:27], v[68:71]
    ds_read_b64_tr_b16 v[56:57], v2 offset:9432
    v_mfma_f32_16x16x32_bf16 v[72:75], v[32:35], v[28:31], v[72:75]
    ds_read_b64_tr_b16 v[58:59], v2 offset:11736
    s_waitcnt lgkmcnt(10)
    v_mfma_f32_16x16x32_bf16 v[76:79], v[36:39], v[24:27], v[76:79]
    ds_read_b64_tr_b16 v[60:61], v2 offset:9440
    v_mfma_f32_16x16x32_bf16 v[80:83], v[36:39], v[28:31], v[80:83]
    ds_read_b64_tr_b16 v[62:63], v2 offset:11744
    s_waitcnt lgkmcnt(10)
    v_mfma_f32_16x16x32_bf16 v[84:87], v[40:43], v[24:27], v[84:87]
    ds_read_b64_tr_b16 v[64:65], v3 offset:9248
    v_mfma_f32_16x16x32_bf16 v[88:91], v[40:43], v[28:31], v[88:91]
    ds_read_b64_tr_b16 v[66:67], v3 offset:11552
    s_barrier
    s_waitcnt lgkmcnt(10)
    v_mfma_f32_16x16x32_bf16 v[92:95], v[44:47], v[24:27], v[92:95]
    ds_read_b128 v[16:19], v4 offset:34816
    ds_read_b128 v[20:23], v4 offset:36864
    v_mfma_f32_16x16x32_bf16 v[96:99], v[44:47], v[28:31], v[96:99]
    ds_read_b64_tr_b16 v[32:33], v2 offset:34816
    ds_read_b64_tr_b16 v[34:35], v2 offset:37120
    s_waitcnt lgkmcnt(12)
    v_mfma_f32_16x16x32_bf16 v[100:103], v[48:51], v[24:27], v[100:103]
    ds_read_b64_tr_b16 v[36:37], v2 offset:34824
    v_mfma_f32_16x16x32_bf16 v[104:107], v[48:51], v[28:31], v[104:107]
    ds_read_b64_tr_b16 v[38:39], v2 offset:37128
    s_waitcnt lgkmcnt(12)
    v_mfma_f32_16x16x32_bf16 v[108:111], v[52:55], v[24:27], v[108:111]
    ds_read_b64_tr_b16 v[40:41], v2 offset:34888
    v_mfma_f32_16x16x32_bf16 v[112:115], v[52:55], v[28:31], v[112:115]
    ds_read_b64_tr_b16 v[42:43], v2 offset:37192
    s_waitcnt lgkmcnt(12)
    v_mfma_f32_16x16x32_bf16 v[116:119], v[56:59], v[24:27], v[116:119]
    ds_read_b64_tr_b16 v[44:45], v2 offset:34896
    v_mfma_f32_16x16x32_bf16 v[120:123], v[56:59], v[28:31], v[120:123]
    ds_read_b64_tr_b16 v[46:47], v2 offset:37200
    s_waitcnt lgkmcnt(12)
    v_mfma_f32_16x16x32_bf16 v[124:127], v[60:63], v[24:27], v[124:127]
    ds_read_b64_tr_b16 v[48:49], v2 offset:34960
    v_mfma_f32_16x16x32_bf16 v[128:131], v[60:63], v[28:31], v[128:131]
    ds_read_b64_tr_b16 v[50:51], v2 offset:37264
    s_waitcnt lgkmcnt(12)
    v_mfma_f32_16x16x32_bf16 v[132:135], v[64:67], v[24:27], v[132:135]
    ds_read_b64_tr_b16 v[52:53], v2 offset:34968
    v_mfma_f32_16x16x32_bf16 v[136:139], v[64:67], v[28:31], v[136:139]
    ds_read_b64_tr_b16 v[54:55], v2 offset:37272
    s_waitcnt lgkmcnt(10)
    v_mfma_f32_16x16x32_bf16 v[68:71], v[32:35], v[16:19], v[68:71]
    ds_read_b64_tr_b16 v[56:57], v2 offset:35032
    v_mfma_f32_16x16x32_bf16 v[72:75], v[32:35], v[20:23], v[72:75]
    ds_read_b64_tr_b16 v[58:59], v2 offset:37336
    s_waitcnt lgkmcnt(10)
    v_mfma_f32_16x16x32_bf16 v[76:79], v[36:39], v[16:19], v[76:79]
    ds_read_b64_tr_b16 v[60:61], v2 offset:35040
    v_mfma_f32_16x16x32_bf16 v[80:83], v[36:39], v[20:23], v[80:83]
    ds_read_b64_tr_b16 v[62:63], v2 offset:37344
    s_waitcnt lgkmcnt(10)
    v_mfma_f32_16x16x32_bf16 v[84:87], v[40:43], v[16:19], v[84:87]
    ds_read_b64_tr_b16 v[64:65], v3 offset:34848
    v_mfma_f32_16x16x32_bf16 v[88:91], v[40:43], v[20:23], v[88:91]
    ds_read_b64_tr_b16 v[66:67], v3 offset:37152
    s_waitcnt lgkmcnt(10)
    v_mfma_f32_16x16x32_bf16 v[92:95], v[44:47], v[16:19], v[92:95]
    ds_read_b128 v[24:27], v5 offset:34816
    ds_read_b128 v[28:31], v5 offset:36864
    v_mfma_f32_16x16x32_bf16 v[96:99], v[44:47], v[20:23], v[96:99]
    ds_read_b64_tr_b16 v[32:33], v2 offset:44032
    ds_read_b64_tr_b16 v[34:35], v2 offset:46336
    s_waitcnt lgkmcnt(12)
    v_mfma_f32_16x16x32_bf16 v[100:103], v[48:51], v[16:19], v[100:103]
    ds_read_b64_tr_b16 v[36:37], v2 offset:44040
    v_mfma_f32_16x16x32_bf16 v[104:107], v[48:51], v[20:23], v[104:107]
    ds_read_b64_tr_b16 v[38:39], v2 offset:46344
    s_waitcnt lgkmcnt(12)
    v_mfma_f32_16x16x32_bf16 v[108:111], v[52:55], v[16:19], v[108:111]
    ds_read_b64_tr_b16 v[40:41], v2 offset:44104
    v_mfma_f32_16x16x32_bf16 v[112:115], v[52:55], v[20:23], v[112:115]
    ds_read_b64_tr_b16 v[42:43], v2 offset:46408
    s_waitcnt lgkmcnt(12)
    v_mfma_f32_16x16x32_bf16 v[116:119], v[56:59], v[16:19], v[116:119]
    ds_read_b64_tr_b16 v[44:45], v2 offset:44112
    v_mfma_f32_16x16x32_bf16 v[120:123], v[56:59], v[20:23], v[120:123]
    ds_read_b64_tr_b16 v[46:47], v2 offset:46416
    s_waitcnt lgkmcnt(12)
    v_mfma_f32_16x16x32_bf16 v[124:127], v[60:63], v[16:19], v[124:127]
    ds_read_b64_tr_b16 v[48:49], v2 offset:44176
    v_mfma_f32_16x16x32_bf16 v[128:131], v[60:63], v[20:23], v[128:131]
    ds_read_b64_tr_b16 v[50:51], v2 offset:46480
    s_waitcnt lgkmcnt(12)
    v_mfma_f32_16x16x32_bf16 v[132:135], v[64:67], v[16:19], v[132:135]
    ds_read_b64_tr_b16 v[52:53], v2 offset:44184
    v_mfma_f32_16x16x32_bf16 v[136:139], v[64:67], v[20:23], v[136:139]
    ds_read_b64_tr_b16 v[54:55], v2 offset:46488
    s_waitcnt lgkmcnt(10)
    v_mfma_f32_16x16x32_bf16 v[68:71], v[32:35], v[24:27], v[68:71]
    ds_read_b64_tr_b16 v[56:57], v2 offset:44248
    v_mfma_f32_16x16x32_bf16 v[72:75], v[32:35], v[28:31], v[72:75]
    ds_read_b64_tr_b16 v[58:59], v2 offset:46552
    s_waitcnt lgkmcnt(10)
    v_mfma_f32_16x16x32_bf16 v[76:79], v[36:39], v[24:27], v[76:79]
    ds_read_b64_tr_b16 v[60:61], v2 offset:44256
    v_mfma_f32_16x16x32_bf16 v[80:83], v[36:39], v[28:31], v[80:83]
    ds_read_b64_tr_b16 v[62:63], v2 offset:46560
    s_waitcnt lgkmcnt(10)
    v_mfma_f32_16x16x32_bf16 v[84:87], v[40:43], v[24:27], v[84:87]
    ds_read_b64_tr_b16 v[64:65], v3 offset:44064
    v_mfma_f32_16x16x32_bf16 v[88:91], v[40:43], v[28:31], v[88:91]
    ds_read_b64_tr_b16 v[66:67], v3 offset:46368
    s_barrier
    s_waitcnt lgkmcnt(10)
    v_mfma_f32_16x16x32_bf16 v[92:95], v[44:47], v[24:27], v[92:95]
    ds_read_b128 v[16:19], v8 offset:0
    ds_read_b128 v[20:23], v8 offset:2048
    v_mfma_f32_16x16x32_bf16 v[96:99], v[44:47], v[28:31], v[96:99]
    ds_read_b64_tr_b16 v[32:33], v6 offset:0
    ds_read_b64_tr_b16 v[34:35], v6 offset:2304
    s_waitcnt lgkmcnt(12)
    v_mfma_f32_16x16x32_bf16 v[100:103], v[48:51], v[24:27], v[100:103]
    ds_read_b64_tr_b16 v[36:37], v6 offset:8
    v_mfma_f32_16x16x32_bf16 v[104:107], v[48:51], v[28:31], v[104:107]
    ds_read_b64_tr_b16 v[38:39], v6 offset:2312
    s_waitcnt lgkmcnt(12)
    v_mfma_f32_16x16x32_bf16 v[108:111], v[52:55], v[24:27], v[108:111]
    ds_read_b64_tr_b16 v[40:41], v6 offset:72
    v_mfma_f32_16x16x32_bf16 v[112:115], v[52:55], v[28:31], v[112:115]
    ds_read_b64_tr_b16 v[42:43], v6 offset:2376
    s_waitcnt lgkmcnt(12)
    v_mfma_f32_16x16x32_bf16 v[116:119], v[56:59], v[24:27], v[116:119]
    ds_read_b64_tr_b16 v[44:45], v6 offset:80
    v_mfma_f32_16x16x32_bf16 v[120:123], v[56:59], v[28:31], v[120:123]
    ds_read_b64_tr_b16 v[46:47], v6 offset:2384
    s_waitcnt lgkmcnt(12)
    v_mfma_f32_16x16x32_bf16 v[124:127], v[60:63], v[24:27], v[124:127]
    ds_read_b64_tr_b16 v[48:49], v6 offset:144
    v_mfma_f32_16x16x32_bf16 v[128:131], v[60:63], v[28:31], v[128:131]
    ds_read_b64_tr_b16 v[50:51], v6 offset:2448
    s_waitcnt lgkmcnt(12)
    v_mfma_f32_16x16x32_bf16 v[132:135], v[64:67], v[24:27], v[132:135]
    ds_read_b64_tr_b16 v[52:53], v6 offset:152
    v_mfma_f32_16x16x32_bf16 v[136:139], v[64:67], v[28:31], v[136:139]
    ds_read_b64_tr_b16 v[54:55], v6 offset:2456
    s_waitcnt lgkmcnt(10)
    v_mfma_f32_16x16x32_bf16 v[68:71], v[32:35], v[16:19], v[68:71]
    ds_read_b64_tr_b16 v[56:57], v6 offset:216
    v_mfma_f32_16x16x32_bf16 v[72:75], v[32:35], v[20:23], v[72:75]
    ds_read_b64_tr_b16 v[58:59], v6 offset:2520
    s_waitcnt lgkmcnt(10)
    v_mfma_f32_16x16x32_bf16 v[76:79], v[36:39], v[16:19], v[76:79]
    ds_read_b64_tr_b16 v[60:61], v6 offset:224
    v_mfma_f32_16x16x32_bf16 v[80:83], v[36:39], v[20:23], v[80:83]
    ds_read_b64_tr_b16 v[62:63], v6 offset:2528
    s_waitcnt lgkmcnt(10)
    v_mfma_f32_16x16x32_bf16 v[84:87], v[40:43], v[16:19], v[84:87]
    ds_read_b64_tr_b16 v[64:65], v7 offset:32
    v_mfma_f32_16x16x32_bf16 v[88:91], v[40:43], v[20:23], v[88:91]
    ds_read_b64_tr_b16 v[66:67], v7 offset:2336
    s_waitcnt lgkmcnt(10)
    v_mfma_f32_16x16x32_bf16 v[92:95], v[44:47], v[16:19], v[92:95]
    ds_read_b128 v[24:27], v9 offset:0
    ds_read_b128 v[28:31], v9 offset:2048
    v_mfma_f32_16x16x32_bf16 v[96:99], v[44:47], v[20:23], v[96:99]
    ds_read_b64_tr_b16 v[32:33], v6 offset:9216
    ds_read_b64_tr_b16 v[34:35], v6 offset:11520
    s_waitcnt lgkmcnt(12)
    v_mfma_f32_16x16x32_bf16 v[100:103], v[48:51], v[16:19], v[100:103]
    ds_read_b64_tr_b16 v[36:37], v6 offset:9224
    v_mfma_f32_16x16x32_bf16 v[104:107], v[48:51], v[20:23], v[104:107]
    ds_read_b64_tr_b16 v[38:39], v6 offset:11528
    s_waitcnt lgkmcnt(12)
    v_mfma_f32_16x16x32_bf16 v[108:111], v[52:55], v[16:19], v[108:111]
    ds_read_b64_tr_b16 v[40:41], v6 offset:9288
    v_mfma_f32_16x16x32_bf16 v[112:115], v[52:55], v[20:23], v[112:115]
    ds_read_b64_tr_b16 v[42:43], v6 offset:11592
    s_waitcnt lgkmcnt(12)
    v_mfma_f32_16x16x32_bf16 v[116:119], v[56:59], v[16:19], v[116:119]
    ds_read_b64_tr_b16 v[44:45], v6 offset:9296
    v_mfma_f32_16x16x32_bf16 v[120:123], v[56:59], v[20:23], v[120:123]
    ds_read_b64_tr_b16 v[46:47], v6 offset:11600
    s_waitcnt lgkmcnt(12)
    v_mfma_f32_16x16x32_bf16 v[124:127], v[60:63], v[16:19], v[124:127]
    ds_read_b64_tr_b16 v[48:49], v6 offset:9360
    v_mfma_f32_16x16x32_bf16 v[128:131], v[60:63], v[20:23], v[128:131]
    ds_read_b64_tr_b16 v[50:51], v6 offset:11664
    s_waitcnt lgkmcnt(12)
    v_mfma_f32_16x16x32_bf16 v[132:135], v[64:67], v[16:19], v[132:135]
    ds_read_b64_tr_b16 v[52:53], v6 offset:9368
    v_mfma_f32_16x16x32_bf16 v[136:139], v[64:67], v[20:23], v[136:139]
    ds_read_b64_tr_b16 v[54:55], v6 offset:11672
    s_waitcnt lgkmcnt(10)
    v_mfma_f32_16x16x32_bf16 v[68:71], v[32:35], v[24:27], v[68:71]
    ds_read_b64_tr_b16 v[56:57], v6 offset:9432
    v_mfma_f32_16x16x32_bf16 v[72:75], v[32:35], v[28:31], v[72:75]
    ds_read_b64_tr_b16 v[58:59], v6 offset:11736
    s_waitcnt lgkmcnt(10)
    v_mfma_f32_16x16x32_bf16 v[76:79], v[36:39], v[24:27], v[76:79]
    ds_read_b64_tr_b16 v[60:61], v6 offset:9440
    v_mfma_f32_16x16x32_bf16 v[80:83], v[36:39], v[28:31], v[80:83]
    ds_read_b64_tr_b16 v[62:63], v6 offset:11744
    s_waitcnt lgkmcnt(10)
    v_mfma_f32_16x16x32_bf16 v[84:87], v[40:43], v[24:27], v[84:87]
    ds_read_b64_tr_b16 v[64:65], v7 offset:9248
    v_mfma_f32_16x16x32_bf16 v[88:91], v[40:43], v[28:31], v[88:91]
    ds_read_b64_tr_b16 v[66:67], v7 offset:11552
    s_barrier
    s_waitcnt lgkmcnt(10)
    v_mfma_f32_16x16x32_bf16 v[92:95], v[44:47], v[24:27], v[92:95]
    ds_read_b128 v[16:19], v8 offset:34816
    ds_read_b128 v[20:23], v8 offset:36864
    v_mfma_f32_16x16x32_bf16 v[96:99], v[44:47], v[28:31], v[96:99]
    ds_read_b64_tr_b16 v[32:33], v6 offset:34816
    ds_read_b64_tr_b16 v[34:35], v6 offset:37120
    s_waitcnt lgkmcnt(12)
    v_mfma_f32_16x16x32_bf16 v[100:103], v[48:51], v[24:27], v[100:103]
    ds_read_b64_tr_b16 v[36:37], v6 offset:34824
    v_mfma_f32_16x16x32_bf16 v[104:107], v[48:51], v[28:31], v[104:107]
    ds_read_b64_tr_b16 v[38:39], v6 offset:37128
    s_waitcnt lgkmcnt(12)
    v_mfma_f32_16x16x32_bf16 v[108:111], v[52:55], v[24:27], v[108:111]
    ds_read_b64_tr_b16 v[40:41], v6 offset:34888
    v_mfma_f32_16x16x32_bf16 v[112:115], v[52:55], v[28:31], v[112:115]
    ds_read_b64_tr_b16 v[42:43], v6 offset:37192
    s_waitcnt lgkmcnt(12)
    v_mfma_f32_16x16x32_bf16 v[116:119], v[56:59], v[24:27], v[116:119]
    ds_read_b64_tr_b16 v[44:45], v6 offset:34896
    v_mfma_f32_16x16x32_bf16 v[120:123], v[56:59], v[28:31], v[120:123]
    ds_read_b64_tr_b16 v[46:47], v6 offset:37200
    s_waitcnt lgkmcnt(12)
    v_mfma_f32_16x16x32_bf16 v[124:127], v[60:63], v[24:27], v[124:127]
    ds_read_b64_tr_b16 v[48:49], v6 offset:34960
    v_mfma_f32_16x16x32_bf16 v[128:131], v[60:63], v[28:31], v[128:131]
    ds_read_b64_tr_b16 v[50:51], v6 offset:37264
    s_waitcnt lgkmcnt(12)
    v_mfma_f32_16x16x32_bf16 v[132:135], v[64:67], v[24:27], v[132:135]
    ds_read_b64_tr_b16 v[52:53], v6 offset:34968
    v_mfma_f32_16x16x32_bf16 v[136:139], v[64:67], v[28:31], v[136:139]
    ds_read_b64_tr_b16 v[54:55], v6 offset:37272
    s_waitcnt lgkmcnt(10)
    v_mfma_f32_16x16x32_bf16 v[68:71], v[32:35], v[16:19], v[68:71]
    ds_read_b64_tr_b16 v[56:57], v6 offset:35032
    v_mfma_f32_16x16x32_bf16 v[72:75], v[32:35], v[20:23], v[72:75]
    ds_read_b64_tr_b16 v[58:59], v6 offset:37336
    s_waitcnt lgkmcnt(10)
    v_mfma_f32_16x16x32_bf16 v[76:79], v[36:39], v[16:19], v[76:79]
    ds_read_b64_tr_b16 v[60:61], v6 offset:35040
    v_mfma_f32_16x16x32_bf16 v[80:83], v[36:39], v[20:23], v[80:83]
    ds_read_b64_tr_b16 v[62:63], v6 offset:37344
    s_waitcnt lgkmcnt(10)
    v_mfma_f32_16x16x32_bf16 v[84:87], v[40:43], v[16:19], v[84:87]
    ds_read_b64_tr_b16 v[64:65], v7 offset:34848
    v_mfma_f32_16x16x32_bf16 v[88:91], v[40:43], v[20:23], v[88:91]
    ds_read_b64_tr_b16 v[66:67], v7 offset:37152
    s_waitcnt lgkmcnt(10)
    v_mfma_f32_16x16x32_bf16 v[92:95], v[44:47], v[16:19], v[92:95]
    ds_read_b128 v[24:27], v9 offset:34816
    ds_read_b128 v[28:31], v9 offset:36864
    v_mfma_f32_16x16x32_bf16 v[96:99], v[44:47], v[20:23], v[96:99]
    ds_read_b64_tr_b16 v[32:33], v6 offset:44032
    ds_read_b64_tr_b16 v[34:35], v6 offset:46336
    s_waitcnt lgkmcnt(12)
    v_mfma_f32_16x16x32_bf16 v[100:103], v[48:51], v[16:19], v[100:103]
    ds_read_b64_tr_b16 v[36:37], v6 offset:44040
    v_mfma_f32_16x16x32_bf16 v[104:107], v[48:51], v[20:23], v[104:107]
    ds_read_b64_tr_b16 v[38:39], v6 offset:46344
    s_waitcnt lgkmcnt(12)
    v_mfma_f32_16x16x32_bf16 v[108:111], v[52:55], v[16:19], v[108:111]
    ds_read_b64_tr_b16 v[40:41], v6 offset:44104
    v_mfma_f32_16x16x32_bf16 v[112:115], v[52:55], v[20:23], v[112:115]
    ds_read_b64_tr_b16 v[42:43], v6 offset:46408
    s_waitcnt lgkmcnt(12)
    v_mfma_f32_16x16x32_bf16 v[116:119], v[56:59], v[16:19], v[116:119]
    ds_read_b64_tr_b16 v[44:45], v6 offset:44112
    v_mfma_f32_16x16x32_bf16 v[120:123], v[56:59], v[20:23], v[120:123]
    ds_read_b64_tr_b16 v[46:47], v6 offset:46416
    s_waitcnt lgkmcnt(12)
    v_mfma_f32_16x16x32_bf16 v[124:127], v[60:63], v[16:19], v[124:127]
    ds_read_b64_tr_b16 v[48:49], v6 offset:44176
    v_mfma_f32_16x16x32_bf16 v[128:131], v[60:63], v[20:23], v[128:131]
    ds_read_b64_tr_b16 v[50:51], v6 offset:46480
    s_waitcnt lgkmcnt(12)
    v_mfma_f32_16x16x32_bf16 v[132:135], v[64:67], v[16:19], v[132:135]
    ds_read_b64_tr_b16 v[52:53], v6 offset:44184
    v_mfma_f32_16x16x32_bf16 v[136:139], v[64:67], v[20:23], v[136:139]
    ds_read_b64_tr_b16 v[54:55], v6 offset:46488
    s_waitcnt lgkmcnt(10)
    v_mfma_f32_16x16x32_bf16 v[68:71], v[32:35], v[24:27], v[68:71]
    ds_read_b64_tr_b16 v[56:57], v6 offset:44248
    v_mfma_f32_16x16x32_bf16 v[72:75], v[32:35], v[28:31], v[72:75]
    ds_read_b64_tr_b16 v[58:59], v6 offset:46552
    s_waitcnt lgkmcnt(10)
    v_mfma_f32_16x16x32_bf16 v[76:79], v[36:39], v[24:27], v[76:79]
    ds_read_b64_tr_b16 v[60:61], v6 offset:44256
    v_mfma_f32_16x16x32_bf16 v[80:83], v[36:39], v[28:31], v[80:83]
    ds_read_b64_tr_b16 v[62:63], v6 offset:46560
    s_waitcnt lgkmcnt(10)
    v_mfma_f32_16x16x32_bf16 v[84:87], v[40:43], v[24:27], v[84:87]
    ds_read_b64_tr_b16 v[64:65], v7 offset:44064
    v_mfma_f32_16x16x32_bf16 v[88:91], v[40:43], v[28:31], v[88:91]
    ds_read_b64_tr_b16 v[66:67], v7 offset:46368
    s_barrier
    s_waitcnt lgkmcnt(10)
    v_mfma_f32_16x16x32_bf16 v[92:95], v[44:47], v[24:27], v[92:95]
    ds_read_b128 v[16:19], v4 offset:0
    ds_read_b128 v[20:23], v4 offset:2048
    v_mfma_f32_16x16x32_bf16 v[96:99], v[44:47], v[28:31], v[96:99]
    ds_read_b64_tr_b16 v[32:33], v2 offset:0
    ds_read_b64_tr_b16 v[34:35], v2 offset:2304
    s_waitcnt lgkmcnt(12)
    v_mfma_f32_16x16x32_bf16 v[100:103], v[48:51], v[24:27], v[100:103]
    ds_read_b64_tr_b16 v[36:37], v2 offset:8
    v_mfma_f32_16x16x32_bf16 v[104:107], v[48:51], v[28:31], v[104:107]
    ds_read_b64_tr_b16 v[38:39], v2 offset:2312
    s_waitcnt lgkmcnt(12)
    v_mfma_f32_16x16x32_bf16 v[108:111], v[52:55], v[24:27], v[108:111]
    ds_read_b64_tr_b16 v[40:41], v2 offset:72
    v_mfma_f32_16x16x32_bf16 v[112:115], v[52:55], v[28:31], v[112:115]
    ds_read_b64_tr_b16 v[42:43], v2 offset:2376
    s_waitcnt lgkmcnt(12)
    v_mfma_f32_16x16x32_bf16 v[116:119], v[56:59], v[24:27], v[116:119]
    ds_read_b64_tr_b16 v[44:45], v2 offset:80
    v_mfma_f32_16x16x32_bf16 v[120:123], v[56:59], v[28:31], v[120:123]
    ds_read_b64_tr_b16 v[46:47], v2 offset:2384
    s_waitcnt lgkmcnt(12)
    v_mfma_f32_16x16x32_bf16 v[124:127], v[60:63], v[24:27], v[124:127]
    ds_read_b64_tr_b16 v[48:49], v2 offset:144
    v_mfma_f32_16x16x32_bf16 v[128:131], v[60:63], v[28:31], v[128:131]
    ds_read_b64_tr_b16 v[50:51], v2 offset:2448
    s_waitcnt lgkmcnt(12)
    v_mfma_f32_16x16x32_bf16 v[132:135], v[64:67], v[24:27], v[132:135]
    ds_read_b64_tr_b16 v[52:53], v2 offset:152
    v_mfma_f32_16x16x32_bf16 v[136:139], v[64:67], v[28:31], v[136:139]
    ds_read_b64_tr_b16 v[54:55], v2 offset:2456
    s_waitcnt lgkmcnt(10)
    v_mfma_f32_16x16x32_bf16 v[68:71], v[32:35], v[16:19], v[68:71]
    ds_read_b64_tr_b16 v[56:57], v2 offset:216
    v_mfma_f32_16x16x32_bf16 v[72:75], v[32:35], v[20:23], v[72:75]
    ds_read_b64_tr_b16 v[58:59], v2 offset:2520
    s_waitcnt lgkmcnt(10)
    v_mfma_f32_16x16x32_bf16 v[76:79], v[36:39], v[16:19], v[76:79]
    ds_read_b64_tr_b16 v[60:61], v2 offset:224
    v_mfma_f32_16x16x32_bf16 v[80:83], v[36:39], v[20:23], v[80:83]
    ds_read_b64_tr_b16 v[62:63], v2 offset:2528
    s_waitcnt lgkmcnt(10)
    v_mfma_f32_16x16x32_bf16 v[84:87], v[40:43], v[16:19], v[84:87]
    ds_read_b64_tr_b16 v[64:65], v3 offset:32
    v_mfma_f32_16x16x32_bf16 v[88:91], v[40:43], v[20:23], v[88:91]
    ds_read_b64_tr_b16 v[66:67], v3 offset:2336
    s_waitcnt lgkmcnt(10)
    v_mfma_f32_16x16x32_bf16 v[92:95], v[44:47], v[16:19], v[92:95]
    ds_read_b128 v[24:27], v5 offset:0
    ds_read_b128 v[28:31], v5 offset:2048
    v_mfma_f32_16x16x32_bf16 v[96:99], v[44:47], v[20:23], v[96:99]
    ds_read_b64_tr_b16 v[32:33], v2 offset:9216
    ds_read_b64_tr_b16 v[34:35], v2 offset:11520
    s_waitcnt lgkmcnt(12)
    v_mfma_f32_16x16x32_bf16 v[100:103], v[48:51], v[16:19], v[100:103]
    ds_read_b64_tr_b16 v[36:37], v2 offset:9224
    v_mfma_f32_16x16x32_bf16 v[104:107], v[48:51], v[20:23], v[104:107]
    ds_read_b64_tr_b16 v[38:39], v2 offset:11528
    s_waitcnt lgkmcnt(12)
    v_mfma_f32_16x16x32_bf16 v[108:111], v[52:55], v[16:19], v[108:111]
    ds_read_b64_tr_b16 v[40:41], v2 offset:9288
    v_mfma_f32_16x16x32_bf16 v[112:115], v[52:55], v[20:23], v[112:115]
    ds_read_b64_tr_b16 v[42:43], v2 offset:11592
    s_waitcnt lgkmcnt(12)
    v_mfma_f32_16x16x32_bf16 v[116:119], v[56:59], v[16:19], v[116:119]
    ds_read_b64_tr_b16 v[44:45], v2 offset:9296
    v_mfma_f32_16x16x32_bf16 v[120:123], v[56:59], v[20:23], v[120:123]
    ds_read_b64_tr_b16 v[46:47], v2 offset:11600
    s_waitcnt lgkmcnt(12)
    v_mfma_f32_16x16x32_bf16 v[124:127], v[60:63], v[16:19], v[124:127]
    ds_read_b64_tr_b16 v[48:49], v2 offset:9360
    v_mfma_f32_16x16x32_bf16 v[128:131], v[60:63], v[20:23], v[128:131]
    ds_read_b64_tr_b16 v[50:51], v2 offset:11664
    s_waitcnt lgkmcnt(12)
    buffer_load_dwordx2 v[236:237], v238, s[52:55], 0 offen sc1
    v_mfma_f32_16x16x32_bf16 v[132:135], v[64:67], v[16:19], v[132:135]
    ds_read_b64_tr_b16 v[52:53], v2 offset:9368
    v_mfma_f32_16x16x32_bf16 v[136:139], v[64:67], v[20:23], v[136:139]
    ds_read_b64_tr_b16 v[54:55], v2 offset:11672
    s_waitcnt lgkmcnt(10)
    v_mfma_f32_16x16x32_bf16 v[68:71], v[32:35], v[24:27], v[68:71]
    ds_read_b64_tr_b16 v[56:57], v2 offset:9432
    v_mfma_f32_16x16x32_bf16 v[72:75], v[32:35], v[28:31], v[72:75]
    ds_read_b64_tr_b16 v[58:59], v2 offset:11736
    s_waitcnt lgkmcnt(10)
    v_mfma_f32_16x16x32_bf16 v[76:79], v[36:39], v[24:27], v[76:79]
    ds_read_b64_tr_b16 v[60:61], v2 offset:9440
    v_mfma_f32_16x16x32_bf16 v[80:83], v[36:39], v[28:31], v[80:83]
    ds_read_b64_tr_b16 v[62:63], v2 offset:11744
    s_waitcnt lgkmcnt(10)
    v_mfma_f32_16x16x32_bf16 v[84:87], v[40:43], v[24:27], v[84:87]
    ds_read_b64_tr_b16 v[64:65], v3 offset:9248
    v_mfma_f32_16x16x32_bf16 v[88:91], v[40:43], v[28:31], v[88:91]
    ds_read_b64_tr_b16 v[66:67], v3 offset:11552
    s_barrier
    s_waitcnt lgkmcnt(10)
    v_mfma_f32_16x16x32_bf16 v[92:95], v[44:47], v[24:27], v[92:95]
    ds_read_b128 v[16:19], v4 offset:34816
    ds_read_b128 v[20:23], v4 offset:36864
    v_mfma_f32_16x16x32_bf16 v[96:99], v[44:47], v[28:31], v[96:99]
    ds_read_b64_tr_b16 v[32:33], v2 offset:34816
    ds_read_b64_tr_b16 v[34:35], v2 offset:37120
    s_waitcnt lgkmcnt(12)
    v_mfma_f32_16x16x32_bf16 v[100:103], v[48:51], v[24:27], v[100:103]
    ds_read_b64_tr_b16 v[36:37], v2 offset:34824
    v_mfma_f32_16x16x32_bf16 v[104:107], v[48:51], v[28:31], v[104:107]
    ds_read_b64_tr_b16 v[38:39], v2 offset:37128
    s_waitcnt lgkmcnt(12)
    v_mfma_f32_16x16x32_bf16 v[108:111], v[52:55], v[24:27], v[108:111]
    ds_read_b64_tr_b16 v[40:41], v2 offset:34888
    v_mfma_f32_16x16x32_bf16 v[112:115], v[52:55], v[28:31], v[112:115]
    ds_read_b64_tr_b16 v[42:43], v2 offset:37192
    s_waitcnt lgkmcnt(12)
    v_mfma_f32_16x16x32_bf16 v[116:119], v[56:59], v[24:27], v[116:119]
    ds_read_b64_tr_b16 v[44:45], v2 offset:34896
    v_mfma_f32_16x16x32_bf16 v[120:123], v[56:59], v[28:31], v[120:123]
    ds_read_b64_tr_b16 v[46:47], v2 offset:37200
    s_waitcnt lgkmcnt(12)
    v_mfma_f32_16x16x32_bf16 v[124:127], v[60:63], v[24:27], v[124:127]
    ds_read_b64_tr_b16 v[48:49], v2 offset:34960
    v_mfma_f32_16x16x32_bf16 v[128:131], v[60:63], v[28:31], v[128:131]
    ds_read_b64_tr_b16 v[50:51], v2 offset:37264
    s_waitcnt lgkmcnt(12)
    v_mfma_f32_16x16x32_bf16 v[132:135], v[64:67], v[24:27], v[132:135]
    ds_read_b64_tr_b16 v[52:53], v2 offset:34968
    v_mfma_f32_16x16x32_bf16 v[136:139], v[64:67], v[28:31], v[136:139]
    ds_read_b64_tr_b16 v[54:55], v2 offset:37272
    s_waitcnt lgkmcnt(10)
    v_mfma_f32_16x16x32_bf16 v[68:71], v[32:35], v[16:19], v[68:71]
    ds_read_b64_tr_b16 v[56:57], v2 offset:35032
    v_mfma_f32_16x16x32_bf16 v[72:75], v[32:35], v[20:23], v[72:75]
    ds_read_b64_tr_b16 v[58:59], v2 offset:37336
    s_waitcnt lgkmcnt(10)
    v_mfma_f32_16x16x32_bf16 v[76:79], v[36:39], v[16:19], v[76:79]
    ds_read_b64_tr_b16 v[60:61], v2 offset:35040
    v_mfma_f32_16x16x32_bf16 v[80:83], v[36:39], v[20:23], v[80:83]
    ds_read_b64_tr_b16 v[62:63], v2 offset:37344
    s_waitcnt lgkmcnt(10)
    v_mfma_f32_16x16x32_bf16 v[84:87], v[40:43], v[16:19], v[84:87]
    ds_read_b64_tr_b16 v[64:65], v3 offset:34848
    v_mfma_f32_16x16x32_bf16 v[88:91], v[40:43], v[20:23], v[88:91]
    ds_read_b64_tr_b16 v[66:67], v3 offset:37152
    s_waitcnt lgkmcnt(10)
    v_mfma_f32_16x16x32_bf16 v[92:95], v[44:47], v[16:19], v[92:95]
    ds_read_b128 v[24:27], v5 offset:34816
    ds_read_b128 v[28:31], v5 offset:36864
    v_mfma_f32_16x16x32_bf16 v[96:99], v[44:47], v[20:23], v[96:99]
    ds_read_b64_tr_b16 v[32:33], v2 offset:44032
    ds_read_b64_tr_b16 v[34:35], v2 offset:46336
    s_waitcnt lgkmcnt(12)
    v_mfma_f32_16x16x32_bf16 v[100:103], v[48:51], v[16:19], v[100:103]
    ds_read_b64_tr_b16 v[36:37], v2 offset:44040
    v_mfma_f32_16x16x32_bf16 v[104:107], v[48:51], v[20:23], v[104:107]
    ds_read_b64_tr_b16 v[38:39], v2 offset:46344
    s_waitcnt lgkmcnt(12)
    v_mfma_f32_16x16x32_bf16 v[108:111], v[52:55], v[16:19], v[108:111]
    ds_read_b64_tr_b16 v[40:41], v2 offset:44104
    v_mfma_f32_16x16x32_bf16 v[112:115], v[52:55], v[20:23], v[112:115]
    ds_read_b64_tr_b16 v[42:43], v2 offset:46408
    s_waitcnt lgkmcnt(12)
    v_mfma_f32_16x16x32_bf16 v[116:119], v[56:59], v[16:19], v[116:119]
    ds_read_b64_tr_b16 v[44:45], v2 offset:44112
    v_mfma_f32_16x16x32_bf16 v[120:123], v[56:59], v[20:23], v[120:123]
    ds_read_b64_tr_b16 v[46:47], v2 offset:46416
    s_waitcnt lgkmcnt(12)
    v_mfma_f32_16x16x32_bf16 v[124:127], v[60:63], v[16:19], v[124:127]
    ds_read_b64_tr_b16 v[48:49], v2 offset:44176
    v_mfma_f32_16x16x32_bf16 v[128:131], v[60:63], v[20:23], v[128:131]
    ds_read_b64_tr_b16 v[50:51], v2 offset:46480
    s_waitcnt lgkmcnt(12)
    v_mfma_f32_16x16x32_bf16 v[132:135], v[64:67], v[16:19], v[132:135]
    ds_read_b64_tr_b16 v[52:53], v2 offset:44184
    v_mfma_f32_16x16x32_bf16 v[136:139], v[64:67], v[20:23], v[136:139]
    ds_read_b64_tr_b16 v[54:55], v2 offset:46488
    s_waitcnt lgkmcnt(10)
    v_mfma_f32_16x16x32_bf16 v[68:71], v[32:35], v[24:27], v[68:71]
    ds_read_b64_tr_b16 v[56:57], v2 offset:44248
    v_mfma_f32_16x16x32_bf16 v[72:75], v[32:35], v[28:31], v[72:75]
    ds_read_b64_tr_b16 v[58:59], v2 offset:46552
    s_waitcnt lgkmcnt(10)
    v_mfma_f32_16x16x32_bf16 v[76:79], v[36:39], v[24:27], v[76:79]
    ds_read_b64_tr_b16 v[60:61], v2 offset:44256
    v_mfma_f32_16x16x32_bf16 v[80:83], v[36:39], v[28:31], v[80:83]
    ds_read_b64_tr_b16 v[62:63], v2 offset:46560
    s_waitcnt lgkmcnt(10)
    v_mfma_f32_16x16x32_bf16 v[84:87], v[40:43], v[24:27], v[84:87]
    ds_read_b64_tr_b16 v[64:65], v3 offset:44064
    v_mfma_f32_16x16x32_bf16 v[88:91], v[40:43], v[28:31], v[88:91]
    ds_read_b64_tr_b16 v[66:67], v3 offset:46368
    s_barrier
    s_waitcnt lgkmcnt(10)
    v_mfma_f32_16x16x32_bf16 v[92:95], v[44:47], v[24:27], v[92:95]
    ds_read_b128 v[16:19], v8 offset:0
    ds_read_b128 v[20:23], v8 offset:2048
    v_mfma_f32_16x16x32_bf16 v[96:99], v[44:47], v[28:31], v[96:99]
    ds_read_b64_tr_b16 v[32:33], v6 offset:0
    ds_read_b64_tr_b16 v[34:35], v6 offset:2304
    s_waitcnt lgkmcnt(12)
    v_mfma_f32_16x16x32_bf16 v[100:103], v[48:51], v[24:27], v[100:103]
    ds_read_b64_tr_b16 v[36:37], v6 offset:8
    v_mfma_f32_16x16x32_bf16 v[104:107], v[48:51], v[28:31], v[104:107]
    ds_read_b64_tr_b16 v[38:39], v6 offset:2312
    s_waitcnt lgkmcnt(12)
    v_mfma_f32_16x16x32_bf16 v[108:111], v[52:55], v[24:27], v[108:111]
    ds_read_b64_tr_b16 v[40:41], v6 offset:72
    v_mfma_f32_16x16x32_bf16 v[112:115], v[52:55], v[28:31], v[112:115]
    ds_read_b64_tr_b16 v[42:43], v6 offset:2376
    s_waitcnt lgkmcnt(12)
    v_mfma_f32_16x16x32_bf16 v[116:119], v[56:59], v[24:27], v[116:119]
    ds_read_b64_tr_b16 v[44:45], v6 offset:80
    v_mfma_f32_16x16x32_bf16 v[120:123], v[56:59], v[28:31], v[120:123]
    ds_read_b64_tr_b16 v[46:47], v6 offset:2384
    s_waitcnt lgkmcnt(12)
    v_mfma_f32_16x16x32_bf16 v[124:127], v[60:63], v[24:27], v[124:127]
    ds_read_b64_tr_b16 v[48:49], v6 offset:144
    v_mfma_f32_16x16x32_bf16 v[128:131], v[60:63], v[28:31], v[128:131]
    ds_read_b64_tr_b16 v[50:51], v6 offset:2448
    s_waitcnt lgkmcnt(12)
    v_mfma_f32_16x16x32_bf16 v[132:135], v[64:67], v[24:27], v[132:135]
    ds_read_b64_tr_b16 v[52:53], v6 offset:152
    v_mfma_f32_16x16x32_bf16 v[136:139], v[64:67], v[28:31], v[136:139]
    ds_read_b64_tr_b16 v[54:55], v6 offset:2456
    s_waitcnt lgkmcnt(10)
    v_mfma_f32_16x16x32_bf16 v[68:71], v[32:35], v[16:19], v[68:71]
    ds_read_b64_tr_b16 v[56:57], v6 offset:216
    v_mfma_f32_16x16x32_bf16 v[72:75], v[32:35], v[20:23], v[72:75]
    ds_read_b64_tr_b16 v[58:59], v6 offset:2520
    s_waitcnt lgkmcnt(10)
    v_mfma_f32_16x16x32_bf16 v[76:79], v[36:39], v[16:19], v[76:79]
    ds_read_b64_tr_b16 v[60:61], v6 offset:224
    v_mfma_f32_16x16x32_bf16 v[80:83], v[36:39], v[20:23], v[80:83]
    ds_read_b64_tr_b16 v[62:63], v6 offset:2528
    s_waitcnt lgkmcnt(10)
    v_mfma_f32_16x16x32_bf16 v[84:87], v[40:43], v[16:19], v[84:87]
    ds_read_b64_tr_b16 v[64:65], v7 offset:32
    v_mfma_f32_16x16x32_bf16 v[88:91], v[40:43], v[20:23], v[88:91]
    ds_read_b64_tr_b16 v[66:67], v7 offset:2336
    s_waitcnt lgkmcnt(10)
    v_mfma_f32_16x16x32_bf16 v[92:95], v[44:47], v[16:19], v[92:95]
    ds_read_b128 v[24:27], v9 offset:0
    ds_read_b128 v[28:31], v9 offset:2048
    v_mfma_f32_16x16x32_bf16 v[96:99], v[44:47], v[20:23], v[96:99]
    ds_read_b64_tr_b16 v[32:33], v6 offset:9216
    ds_read_b64_tr_b16 v[34:35], v6 offset:11520
    s_waitcnt lgkmcnt(12)
    v_mfma_f32_16x16x32_bf16 v[100:103], v[48:51], v[16:19], v[100:103]
    ds_read_b64_tr_b16 v[36:37], v6 offset:9224
    v_mfma_f32_16x16x32_bf16 v[104:107], v[48:51], v[20:23], v[104:107]
    ds_read_b64_tr_b16 v[38:39], v6 offset:11528
    s_waitcnt lgkmcnt(12)
    v_mfma_f32_16x16x32_bf16 v[108:111], v[52:55], v[16:19], v[108:111]
    ds_read_b64_tr_b16 v[40:41], v6 offset:9288
    v_mfma_f32_16x16x32_bf16 v[112:115], v[52:55], v[20:23], v[112:115]
    ds_read_b64_tr_b16 v[42:43], v6 offset:11592
    s_waitcnt lgkmcnt(12)
    v_mfma_f32_16x16x32_bf16 v[116:119], v[56:59], v[16:19], v[116:119]
    ds_read_b64_tr_b16 v[44:45], v6 offset:9296
    v_mfma_f32_16x16x32_bf16 v[120:123], v[56:59], v[20:23], v[120:123]
    ds_read_b64_tr_b16 v[46:47], v6 offset:11600
    s_waitcnt lgkmcnt(12)
    v_mfma_f32_16x16x32_bf16 v[124:127], v[60:63], v[16:19], v[124:127]
    ds_read_b64_tr_b16 v[48:49], v6 offset:9360
    v_mfma_f32_16x16x32_bf16 v[128:131], v[60:63], v[20:23], v[128:131]
    ds_read_b64_tr_b16 v[50:51], v6 offset:11664
    s_waitcnt lgkmcnt(12)
    v_mfma_f32_16x16x32_bf16 v[132:135], v[64:67], v[16:19], v[132:135]
    ds_read_b64_tr_b16 v[52:53], v6 offset:9368
    v_mfma_f32_16x16x32_bf16 v[136:139], v[64:67], v[20:23], v[136:139]
    ds_read_b64_tr_b16 v[54:55], v6 offset:11672
    s_waitcnt lgkmcnt(10)
    v_mfma_f32_16x16x32_bf16 v[68:71], v[32:35], v[24:27], v[68:71]
    ds_read_b64_tr_b16 v[56:57], v6 offset:9432
    v_mfma_f32_16x16x32_bf16 v[72:75], v[32:35], v[28:31], v[72:75]
    ds_read_b64_tr_b16 v[58:59], v6 offset:11736
    s_waitcnt lgkmcnt(10)
    v_mfma_f32_16x16x32_bf16 v[76:79], v[36:39], v[24:27], v[76:79]
    ds_read_b64_tr_b16 v[60:61], v6 offset:9440
    v_mfma_f32_16x16x32_bf16 v[80:83], v[36:39], v[28:31], v[80:83]
    ds_read_b64_tr_b16 v[62:63], v6 offset:11744
    s_waitcnt lgkmcnt(10)
    v_mfma_f32_16x16x32_bf16 v[84:87], v[40:43], v[24:27], v[84:87]
    ds_read_b64_tr_b16 v[64:65], v7 offset:9248
    v_mfma_f32_16x16x32_bf16 v[88:91], v[40:43], v[28:31], v[88:91]
    ds_read_b64_tr_b16 v[66:67], v7 offset:11552
    s_barrier
    s_waitcnt lgkmcnt(10)
    v_mfma_f32_16x16x32_bf16 v[92:95], v[44:47], v[24:27], v[92:95]
    ds_read_b128 v[16:19], v8 offset:34816
    ds_read_b128 v[20:23], v8 offset:36864
    v_mfma_f32_16x16x32_bf16 v[96:99], v[44:47], v[28:31], v[96:99]
    ds_read_b64_tr_b16 v[32:33], v6 offset:34816
    ds_read_b64_tr_b16 v[34:35], v6 offset:37120
    s_waitcnt lgkmcnt(12)
    v_mfma_f32_16x16x32_bf16 v[100:103], v[48:51], v[24:27], v[100:103]
    ds_read_b64_tr_b16 v[36:37], v6 offset:34824
    v_mfma_f32_16x16x32_bf16 v[104:107], v[48:51], v[28:31], v[104:107]
    ds_read_b64_tr_b16 v[38:39], v6 offset:37128
    s_waitcnt lgkmcnt(12)
    v_mfma_f32_16x16x32_bf16 v[108:111], v[52:55], v[24:27], v[108:111]
    ds_read_b64_tr_b16 v[40:41], v6 offset:34888
    v_mfma_f32_16x16x32_bf16 v[112:115], v[52:55], v[28:31], v[112:115]
    ds_read_b64_tr_b16 v[42:43], v6 offset:37192
    s_waitcnt lgkmcnt(12)
    v_mfma_f32_16x16x32_bf16 v[116:119], v[56:59], v[24:27], v[116:119]
    ds_read_b64_tr_b16 v[44:45], v6 offset:34896
    v_mfma_f32_16x16x32_bf16 v[120:123], v[56:59], v[28:31], v[120:123]
    ds_read_b64_tr_b16 v[46:47], v6 offset:37200
    s_waitcnt lgkmcnt(12)
    v_mfma_f32_16x16x32_bf16 v[124:127], v[60:63], v[24:27], v[124:127]
    ds_read_b64_tr_b16 v[48:49], v6 offset:34960
    v_mfma_f32_16x16x32_bf16 v[128:131], v[60:63], v[28:31], v[128:131]
    ds_read_b64_tr_b16 v[50:51], v6 offset:37264
    s_waitcnt lgkmcnt(12)
    v_mfma_f32_16x16x32_bf16 v[132:135], v[64:67], v[24:27], v[132:135]
    ds_read_b64_tr_b16 v[52:53], v6 offset:34968
    v_mfma_f32_16x16x32_bf16 v[136:139], v[64:67], v[28:31], v[136:139]
    ds_read_b64_tr_b16 v[54:55], v6 offset:37272
    s_waitcnt lgkmcnt(10)
    v_mfma_f32_16x16x32_bf16 v[68:71], v[32:35], v[16:19], v[68:71]
    ds_read_b64_tr_b16 v[56:57], v6 offset:35032
    v_mfma_f32_16x16x32_bf16 v[72:75], v[32:35], v[20:23], v[72:75]
    ds_read_b64_tr_b16 v[58:59], v6 offset:37336
    s_waitcnt lgkmcnt(10)
    v_mfma_f32_16x16x32_bf16 v[76:79], v[36:39], v[16:19], v[76:79]
    ds_read_b64_tr_b16 v[60:61], v6 offset:35040
    v_mfma_f32_16x16x32_bf16 v[80:83], v[36:39], v[20:23], v[80:83]
    ds_read_b64_tr_b16 v[62:63], v6 offset:37344
    s_waitcnt lgkmcnt(10)
    v_mfma_f32_16x16x32_bf16 v[84:87], v[40:43], v[16:19], v[84:87]
    ds_read_b64_tr_b16 v[64:65], v7 offset:34848
    v_mfma_f32_16x16x32_bf16 v[88:91], v[40:43], v[20:23], v[88:91]
    ds_read_b64_tr_b16 v[66:67], v7 offset:37152
    s_waitcnt lgkmcnt(10)
    v_mfma_f32_16x16x32_bf16 v[92:95], v[44:47], v[16:19], v[92:95]
    ds_read_b128 v[24:27], v9 offset:34816
    ds_read_b128 v[28:31], v9 offset:36864
    v_mfma_f32_16x16x32_bf16 v[96:99], v[44:47], v[20:23], v[96:99]
    ds_read_b64_tr_b16 v[32:33], v6 offset:44032
    ds_read_b64_tr_b16 v[34:35], v6 offset:46336
    s_waitcnt lgkmcnt(12)
    v_mfma_f32_16x16x32_bf16 v[100:103], v[48:51], v[16:19], v[100:103]
    ds_read_b64_tr_b16 v[36:37], v6 offset:44040
    v_mfma_f32_16x16x32_bf16 v[104:107], v[48:51], v[20:23], v[104:107]
    ds_read_b64_tr_b16 v[38:39], v6 offset:46344
    s_waitcnt lgkmcnt(12)
    v_mfma_f32_16x16x32_bf16 v[108:111], v[52:55], v[16:19], v[108:111]
    ds_read_b64_tr_b16 v[40:41], v6 offset:44104
    v_mfma_f32_16x16x32_bf16 v[112:115], v[52:55], v[20:23], v[112:115]
    ds_read_b64_tr_b16 v[42:43], v6 offset:46408
    s_waitcnt lgkmcnt(12)
    v_mfma_f32_16x16x32_bf16 v[116:119], v[56:59], v[16:19], v[116:119]
    ds_read_b64_tr_b16 v[44:45], v6 offset:44112
    v_mfma_f32_16x16x32_bf16 v[120:123], v[56:59], v[20:23], v[120:123]
    ds_read_b64_tr_b16 v[46:47], v6 offset:46416
    s_waitcnt lgkmcnt(12)
    v_mfma_f32_16x16x32_bf16 v[124:127], v[60:63], v[16:19], v[124:127]
    ds_read_b64_tr_b16 v[48:49], v6 offset:44176
    v_mfma_f32_16x16x32_bf16 v[128:131], v[60:63], v[20:23], v[128:131]
    ds_read_b64_tr_b16 v[50:51], v6 offset:46480
    s_waitcnt lgkmcnt(12)
    v_mfma_f32_16x16x32_bf16 v[132:135], v[64:67], v[16:19], v[132:135]
    ds_read_b64_tr_b16 v[52:53], v6 offset:44184
    v_mfma_f32_16x16x32_bf16 v[136:139], v[64:67], v[20:23], v[136:139]
    ds_read_b64_tr_b16 v[54:55], v6 offset:46488
    s_waitcnt lgkmcnt(10)
    v_mfma_f32_16x16x32_bf16 v[68:71], v[32:35], v[24:27], v[68:71]
    ds_read_b64_tr_b16 v[56:57], v6 offset:44248
    v_mfma_f32_16x16x32_bf16 v[72:75], v[32:35], v[28:31], v[72:75]
    ds_read_b64_tr_b16 v[58:59], v6 offset:46552
    s_waitcnt lgkmcnt(10)
    v_mfma_f32_16x16x32_bf16 v[76:79], v[36:39], v[24:27], v[76:79]
    ds_read_b64_tr_b16 v[60:61], v6 offset:44256
    v_mfma_f32_16x16x32_bf16 v[80:83], v[36:39], v[28:31], v[80:83]
    ds_read_b64_tr_b16 v[62:63], v6 offset:46560
    s_waitcnt lgkmcnt(10)
    v_mfma_f32_16x16x32_bf16 v[84:87], v[40:43], v[24:27], v[84:87]
    ds_read_b64_tr_b16 v[64:65], v7 offset:44064
    v_mfma_f32_16x16x32_bf16 v[88:91], v[40:43], v[28:31], v[88:91]
    ds_read_b64_tr_b16 v[66:67], v7 offset:46368
    s_barrier
    s_waitcnt lgkmcnt(10)
    v_mfma_f32_16x16x32_bf16 v[92:95], v[44:47], v[24:27], v[92:95]
    ds_read_b128 v[16:19], v4 offset:0
    ds_read_b128 v[20:23], v4 offset:2048
    v_mfma_f32_16x16x32_bf16 v[96:99], v[44:47], v[28:31], v[96:99]
    ds_read_b64_tr_b16 v[32:33], v2 offset:0
    ds_read_b64_tr_b16 v[34:35], v2 offset:2304
    s_waitcnt lgkmcnt(12)
    v_mfma_f32_16x16x32_bf16 v[100:103], v[48:51], v[24:27], v[100:103]
    ds_read_b128 v[140:143], v5 offset:0
    ds_read_b128 v[144:147], v5 offset:2048
    v_mfma_f32_16x16x32_bf16 v[104:107], v[48:51], v[28:31], v[104:107]
    ds_read_b64_tr_b16 v[36:37], v2 offset:9216
    s_waitcnt lgkmcnt(13)
    ds_read_b64_tr_b16 v[38:39], v2 offset:11520
    v_mfma_f32_16x16x32_bf16 v[108:111], v[52:55], v[24:27], v[108:111]
    ds_read_b64_tr_b16 v[40:41], v2 offset:8
    v_mfma_f32_16x16x32_bf16 v[112:115], v[52:55], v[28:31], v[112:115]
    s_waitcnt lgkmcnt(13)
    ds_read_b64_tr_b16 v[42:43], v2 offset:2312
    v_mfma_f32_16x16x32_bf16 v[116:119], v[56:59], v[24:27], v[116:119]
    ds_read_b64_tr_b16 v[44:45], v2 offset:9224
    v_mfma_f32_16x16x32_bf16 v[120:123], v[56:59], v[28:31], v[120:123]
    s_waitcnt lgkmcnt(13)
    ds_read_b64_tr_b16 v[46:47], v2 offset:11528
    v_mfma_f32_16x16x32_bf16 v[124:127], v[60:63], v[24:27], v[124:127]
    ds_read_b64_tr_b16 v[48:49], v2 offset:72
    v_mfma_f32_16x16x32_bf16 v[128:131], v[60:63], v[28:31], v[128:131]
    s_waitcnt lgkmcnt(13)
    ds_read_b64_tr_b16 v[50:51], v2 offset:2376
    v_mfma_f32_16x16x32_bf16 v[132:135], v[64:67], v[24:27], v[132:135]
    ds_read_b64_tr_b16 v[52:53], v2 offset:9288
    v_mfma_f32_16x16x32_bf16 v[136:139], v[64:67], v[28:31], v[136:139]
    s_waitcnt lgkmcnt(11)
    ds_read_b64_tr_b16 v[54:55], v2 offset:11592
    s_mov_b32 s8, 0
    s_mov_b32 s10, 0x3eae1a93
    s_cmp_lg_u32 s4, 0
    s_cbranch_scc1 GC_NOSCALE
    v_mfma_f32_16x16x32_bf16 v[68:71], v[32:35], v[16:19], v[68:71]
    ds_read_b64_tr_b16 v[56:57], v2 offset:80
    v_mfma_f32_16x16x32_bf16 v[72:75], v[32:35], v[20:23], v[72:75]
    ds_read_b64_tr_b16 v[58:59], v2 offset:2384
    s_waitcnt lgkmcnt(10)
    v_mfma_f32_16x16x32_bf16 v[68:71], v[36:39], v[140:143], v[68:71]
    ds_read_b64_tr_b16 v[60:61], v2 offset:9296
    v_mfma_f32_16x16x32_bf16 v[72:75], v[36:39], v[144:147], v[72:75]
    ds_read_b64_tr_b16 v[62:63], v2 offset:11600
    s_waitcnt lgkmcnt(10)
    v_mfma_f32_16x16x32_bf16 v[76:79], v[40:43], v[16:19], v[76:79]
    ds_read_b64_tr_b16 v[64:65], v2 offset:144
    v_mfma_f32_16x16x32_bf16 v[80:83], v[40:43], v[20:23], v[80:83]
    ds_read_b64_tr_b16 v[66:67], v2 offset:2448
    s_waitcnt lgkmcnt(10)
    v_mfma_f32_16x16x32_bf16 v[76:79], v[44:47], v[140:143], v[76:79]
    ds_read_b64_tr_b16 v[32:33], v2 offset:9360
    v_mul_f32 v68, s10, v68
    v_mul_f32 v69, s10, v69
    v_mul_f32 v70, s10, v70
    v_mul_f32 v71, s10, v71
    v_mfma_f32_16x16x32_bf16 v[80:83], v[44:47], v[144:147], v[80:83]
    ds_read_b64_tr_b16 v[34:35], v2 offset:11664
    v_cvt_pk_bf16_f32 v148, v68, v69
    v_cvt_pk_bf16_f32 v149, v70, v71
    v_mul_f32 v72, s10, v72
    v_mul_f32 v73, s10, v73
    s_waitcnt lgkmcnt(10)
    v_mfma_f32_16x16x32_bf16 v[84:87], v[48:51], v[16:19], v[84:87]
    ds_read_b64_tr_b16 v[36:37], v2 offset:152
    v_mul_f32 v74, s10, v74
    v_mul_f32 v75, s10, v75
    v_cvt_pk_bf16_f32 v152, v72, v73
    v_cvt_pk_bf16_f32 v153, v74, v75
    v_mfma_f32_16x16x32_bf16 v[88:91], v[48:51], v[20:23], v[88:91]
    ds_read_b64_tr_b16 v[38:39], v2 offset:2456
    s_waitcnt lgkmcnt(10)
    v_mfma_f32_16x16x32_bf16 v[84:87], v[52:55], v[140:143], v[84:87]
    ds_read_b64_tr_b16 v[40:41], v2 offset:9368
    v_mul_f32 v76, s10, v76
    v_mul_f32 v77, s10, v77
    v_mul_f32 v78, s10, v78
    v_mul_f32 v79, s10, v79
    v_mfma_f32_16x16x32_bf16 v[88:91], v[52:55], v[144:147], v[88:91]
    ds_read_b64_tr_b16 v[42:43], v2 offset:11672
    v_cvt_pk_bf16_f32 v150, v76, v77
    v_cvt_pk_bf16_f32 v151, v78, v79
    buffer_store_dwordx4 v[148:151], v10, s[40:43], s8 offen offset:0 sc1
    v_mul_f32 v80, s10, v80
    s_waitcnt lgkmcnt(10)
    v_mfma_f32_16x16x32_bf16 v[92:95], v[56:59], v[16:19], v[92:95]
    ds_read_b64_tr_b16 v[44:45], v2 offset:216
    v_mul_f32 v81, s10, v81
    v_mul_f32 v82, s10, v82
    v_mul_f32 v83, s10, v83
    v_cvt_pk_bf16_f32 v154, v80, v81
    v_mfma_f32_16x16x32_bf16 v[96:99], v[56:59], v[20:23], v[96:99]
    ds_read_b64_tr_b16 v[46:47], v2 offset:2520
    v_cvt_pk_bf16_f32 v155, v82, v83
    buffer_store_dwordx4 v[152:155], v10, s[40:43], s8 offen offset:128 sc1
    s_add_u32 s8, s8, s9
    s_waitcnt lgkmcnt(10)
    v_mfma_f32_16x16x32_bf16 v[92:95], v[60:63], v[140:143], v[92:95]
    ds_read_b64_tr_b16 v[48:49], v2 offset:9432
    v_mul_f32 v84, s10, v84
    v_mul_f32 v85, s10, v85
    v_mul_f32 v86, s10, v86
    v_mul_f32 v87, s10, v87
    v_mfma_f32_16x16x32_bf16 v[96:99], v[60:63], v[144:147], v[96:99]
    ds_read_b64_tr_b16 v[50:51], v2 offset:11736
    v_cvt_pk_bf16_f32 v156, v84, v85
    v_cvt_pk_bf16_f32 v157, v86, v87
    v_mul_f32 v88, s10, v88
    v_mul_f32 v89, s10, v89
    s_waitcnt lgkmcnt(10)
    v_mfma_f32_16x16x32_bf16 v[100:103], v[64:67], v[16:19], v[100:103]
    ds_read_b64_tr_b16 v[52:53], v2 offset:224
    v_mul_f32 v90, s10, v90
    v_mul_f32 v91, s10, v91
    v_cvt_pk_bf16_f32 v160, v88, v89
    v_cvt_pk_bf16_f32 v161, v90, v91
    v_mfma_f32_16x16x32_bf16 v[104:107], v[64:67], v[20:23], v[104:107]
    ds_read_b64_tr_b16 v[54:55], v2 offset:2528
    s_waitcnt lgkmcnt(10)
    v_mfma_f32_16x16x32_bf16 v[100:103], v[32:35], v[140:143], v[100:103]
    ds_read_b64_tr_b16 v[56:57], v2 offset:9440
    v_mul_f32 v92, s10, v92
    v_mul_f32 v93, s10, v93
    v_mul_f32 v94, s10, v94
    v_mul_f32 v95, s10, v95
    v_mfma_f32_16x16x32_bf16 v[104:107], v[32:35], v[144:147], v[104:107]
    ds_read_b64_tr_b16 v[58:59], v2 offset:11744
    v_cvt_pk_bf16_f32 v158, v92, v93
    v_cvt_pk_bf16_f32 v159, v94, v95
    buffer_store_dwordx4 v[156:159], v10, s[40:43], s8 offen offset:0 sc1
    v_mul_f32 v96, s10, v96
    s_waitcnt lgkmcnt(10)
    v_mfma_f32_16x16x32_bf16 v[108:111], v[36:39], v[16:19], v[108:111]
    ds_read_b64_tr_b16 v[60:61], v3 offset:32
    v_mul_f32 v97, s10, v97
    v_mul_f32 v98, s10, v98
    v_mul_f32 v99, s10, v99
    v_cvt_pk_bf16_f32 v162, v96, v97
    v_mfma_f32_16x16x32_bf16 v[112:115], v[36:39], v[20:23], v[112:115]
    ds_read_b64_tr_b16 v[62:63], v3 offset:2336
    v_cvt_pk_bf16_f32 v163, v98, v99
    buffer_store_dwordx4 v[160:163], v10, s[40:43], s8 offen offset:128 sc1
    s_add_u32 s8, s8, s9
    s_waitcnt lgkmcnt(10)
    v_mfma_f32_16x16x32_bf16 v[108:111], v[40:43], v[140:143], v[108:111]
    ds_read_b64_tr_b16 v[64:65], v3 offset:9248
    v_mul_f32 v100, s10, v100
    v_mul_f32 v101, s10, v101
    v_mul_f32 v102, s10, v102
    v_mul_f32 v103, s10, v103
    v_mfma_f32_16x16x32_bf16 v[112:115], v[40:43], v[144:147], v[112:115]
    ds_read_b64_tr_b16 v[66:67], v3 offset:11552
    v_cvt_pk_bf16_f32 v164, v100, v101
    v_cvt_pk_bf16_f32 v165, v102, v103
    v_mul_f32 v104, s10, v104
    v_mul_f32 v105, s10, v105
    s_waitcnt lgkmcnt(10)
    v_mfma_f32_16x16x32_bf16 v[116:119], v[44:47], v[16:19], v[116:119]
    v_mul_f32 v106, s10, v106
    v_mul_f32 v107, s10, v107
    v_cvt_pk_bf16_f32 v168, v104, v105
    v_cvt_pk_bf16_f32 v169, v106, v107
    v_mfma_f32_16x16x32_bf16 v[120:123], v[44:47], v[20:23], v[120:123]
    s_waitcnt lgkmcnt(8)
    v_mfma_f32_16x16x32_bf16 v[116:119], v[48:51], v[140:143], v[116:119]
    v_mul_f32 v108, s10, v108
    v_mul_f32 v109, s10, v109
    v_mul_f32 v110, s10, v110
    v_mul_f32 v111, s10, v111
    v_mfma_f32_16x16x32_bf16 v[120:123], v[48:51], v[144:147], v[120:123]
    v_cvt_pk_bf16_f32 v166, v108, v109
    v_cvt_pk_bf16_f32 v167, v110, v111
    buffer_store_dwordx4 v[164:167], v10, s[40:43], s8 offen offset:0 sc1
    v_mul_f32 v112, s10, v112
    s_waitcnt lgkmcnt(6)
    v_mfma_f32_16x16x32_bf16 v[124:127], v[52:55], v[16:19], v[124:127]
    v_mul_f32 v113, s10, v113
    v_mul_f32 v114, s10, v114
    v_mul_f32 v115, s10, v115
    v_cvt_pk_bf16_f32 v170, v112, v113
    v_mfma_f32_16x16x32_bf16 v[128:131], v[52:55], v[20:23], v[128:131]
    v_cvt_pk_bf16_f32 v171, v114, v115
    buffer_store_dwordx4 v[168:171], v10, s[40:43], s8 offen offset:128 sc1
    s_add_u32 s8, s8, s9
    s_waitcnt lgkmcnt(4)
    v_mfma_f32_16x16x32_bf16 v[124:127], v[56:59], v[140:143], v[124:127]
    v_mul_f32 v116, s10, v116
    v_mul_f32 v117, s10, v117
    v_mul_f32 v118, s10, v118
    v_mul_f32 v119, s10, v119
    v_mfma_f32_16x16x32_bf16 v[128:131], v[56:59], v[144:147], v[128:131]
    v_cvt_pk_bf16_f32 v172, v116, v117
    v_cvt_pk_bf16_f32 v173, v118, v119
    v_mul_f32 v120, s10, v120
    v_mul_f32 v121, s10, v121
    s_waitcnt lgkmcnt(2)
    v_mfma_f32_16x16x32_bf16 v[132:135], v[60:63], v[16:19], v[132:135]
    v_mul_f32 v122, s10, v122
    v_mul_f32 v123, s10, v123
    v_cvt_pk_bf16_f32 v176, v120, v121
    v_cvt_pk_bf16_f32 v177, v122, v123
    v_mfma_f32_16x16x32_bf16 v[136:139], v[60:63], v[20:23], v[136:139]
    s_waitcnt lgkmcnt(0)
    v_mfma_f32_16x16x32_bf16 v[132:135], v[64:67], v[140:143], v[132:135]
    v_mul_f32 v124, s10, v124
    v_mul_f32 v125, s10, v125
    v_mul_f32 v126, s10, v126
    v_mul_f32 v127, s10, v127
    v_mfma_f32_16x16x32_bf16 v[136:139], v[64:67], v[144:147], v[136:139]
    v_cvt_pk_bf16_f32 v174, v124, v125
    v_cvt_pk_bf16_f32 v175, v126, v127
    buffer_store_dwordx4 v[172:175], v10, s[40:43], s8 offen offset:0 sc1
    v_mul_f32 v128, s10, v128
    v_mul_f32 v129, s10, v129
    v_mul_f32 v130, s10, v130
    v_mul_f32 v131, s10, v131
    v_cvt_pk_bf16_f32 v178, v128, v129
    v_cvt_pk_bf16_f32 v179, v130, v131
    buffer_store_dwordx4 v[176:179], v10, s[40:43], s8 offen offset:128 sc1
    v_mul_f32 v132, s10, v132
    v_mul_f32 v133, s10, v133
    v_mul_f32 v134, s10, v134
    v_mul_f32 v135, s10, v135
    v_cvt_pk_bf16_f32 v180, v132, v133
    v_cvt_pk_bf16_f32 v181, v134, v135
    v_mul_f32 v136, s10, v136
    v_mul_f32 v137, s10, v137
    v_mul_f32 v138, s10, v138
    v_mul_f32 v139, s10, v139
    v_cvt_pk_bf16_f32 v182, v136, v137
    v_cvt_pk_bf16_f32 v183, v138, v139
    buffer_store_dwordx4 v[180:183], v11, s[40:43], 0 offen sc1
    s_branch GC_POST
GC_NOSCALE:
    v_mfma_f32_16x16x32_bf16 v[68:71], v[32:35], v[16:19], v[68:71]
    ds_read_b64_tr_b16 v[56:57], v2 offset:80
    v_mfma_f32_16x16x32_bf16 v[72:75], v[32:35], v[20:23], v[72:75]
    ds_read_b64_tr_b16 v[58:59], v2 offset:2384
    s_waitcnt lgkmcnt(10)
    v_mfma_f32_16x16x32_bf16 v[68:71], v[36:39], v[140:143], v[68:71]
    ds_read_b64_tr_b16 v[60:61], v2 offset:9296
    v_mfma_f32_16x16x32_bf16 v[72:75], v[36:39], v[144:147], v[72:75]
    ds_read_b64_tr_b16 v[62:63], v2 offset:11600
    s_waitcnt lgkmcnt(10)
    v_mfma_f32_16x16x32_bf16 v[76:79], v[40:43], v[16:19], v[76:79]
    ds_read_b64_tr_b16 v[64:65], v2 offset:144
    v_mfma_f32_16x16x32_bf16 v[80:83], v[40:43], v[20:23], v[80:83]
    ds_read_b64_tr_b16 v[66:67], v2 offset:2448
    s_waitcnt lgkmcnt(10)
    v_mfma_f32_16x16x32_bf16 v[76:79], v[44:47], v[140:143], v[76:79]
    ds_read_b64_tr_b16 v[32:33], v2 offset:9360
    v_cvt_pk_bf16_f32 v148, v68, v69
    v_cvt_pk_bf16_f32 v149, v70, v71
    v_mfma_f32_16x16x32_bf16 v[80:83], v[44:47], v[144:147], v[80:83]
    ds_read_b64_tr_b16 v[34:35], v2 offset:11664
    v_cvt_pk_bf16_f32 v152, v72, v73
    v_cvt_pk_bf16_f32 v153, v74, v75
    s_waitcnt lgkmcnt(10)
    v_mfma_f32_16x16x32_bf16 v[84:87], v[48:51], v[16:19], v[84:87]
    ds_read_b64_tr_b16 v[36:37], v2 offset:152
    v_mfma_f32_16x16x32_bf16 v[88:91], v[48:51], v[20:23], v[88:91]
    ds_read_b64_tr_b16 v[38:39], v2 offset:2456
    s_waitcnt lgkmcnt(10)
    v_mfma_f32_16x16x32_bf16 v[84:87], v[52:55], v[140:143], v[84:87]
    ds_read_b64_tr_b16 v[40:41], v2 offset:9368
    v_cvt_pk_bf16_f32 v150, v76, v77
    v_cvt_pk_bf16_f32 v151, v78, v79
    v_mfma_f32_16x16x32_bf16 v[88:91], v[52:55], v[144:147], v[88:91]
    ds_read_b64_tr_b16 v[42:43], v2 offset:11672
    buffer_store_dwordx4 v[148:151], v10, s[40:43], s8 offen offset:0 sc1
    v_cvt_pk_bf16_f32 v154, v80, v81
    s_waitcnt lgkmcnt(10)
    v_mfma_f32_16x16x32_bf16 v[92:95], v[56:59], v[16:19], v[92:95]
    ds_read_b64_tr_b16 v[44:45], v2 offset:216
    v_cvt_pk_bf16_f32 v155, v82, v83
    buffer_store_dwordx4 v[152:155], v10, s[40:43], s8 offen offset:128 sc1
    v_mfma_f32_16x16x32_bf16 v[96:99], v[56:59], v[20:23], v[96:99]
    ds_read_b64_tr_b16 v[46:47], v2 offset:2520
    s_add_u32 s8, s8, s9
    s_waitcnt lgkmcnt(10)
    v_mfma_f32_16x16x32_bf16 v[92:95], v[60:63], v[140:143], v[92:95]
    ds_read_b64_tr_b16 v[48:49], v2 offset:9432
    v_cvt_pk_bf16_f32 v156, v84, v85
    v_cvt_pk_bf16_f32 v157, v86, v87
    v_mfma_f32_16x16x32_bf16 v[96:99], v[60:63], v[144:147], v[96:99]
    ds_read_b64_tr_b16 v[50:51], v2 offset:11736
    v_cvt_pk_bf16_f32 v160, v88, v89
    v_cvt_pk_bf16_f32 v161, v90, v91
    s_waitcnt lgkmcnt(10)
    v_mfma_f32_16x16x32_bf16 v[100:103], v[64:67], v[16:19], v[100:103]
    ds_read_b64_tr_b16 v[52:53], v2 offset:224
    v_mfma_f32_16x16x32_bf16 v[104:107], v[64:67], v[20:23], v[104:107]
    ds_read_b64_tr_b16 v[54:55], v2 offset:2528
    s_waitcnt lgkmcnt(10)
    v_mfma_f32_16x16x32_bf16 v[100:103], v[32:35], v[140:143], v[100:103]
    ds_read_b64_tr_b16 v[56:57], v2 offset:9440
    v_cvt_pk_bf16_f32 v158, v92, v93
    v_cvt_pk_bf16_f32 v159, v94, v95
    v_mfma_f32_16x16x32_bf16 v[104:107], v[32:35], v[144:147], v[104:107]
    ds_read_b64_tr_b16 v[58:59], v2 offset:11744
    buffer_store_dwordx4 v[156:159], v10, s[40:43], s8 offen offset:0 sc1
    v_cvt_pk_bf16_f32 v162, v96, v97
    s_waitcnt lgkmcnt(10)
    v_mfma_f32_16x16x32_bf16 v[108:111], v[36:39], v[16:19], v[108:111]
    ds_read_b64_tr_b16 v[60:61], v3 offset:32
    v_cvt_pk_bf16_f32 v163, v98, v99
    buffer_store_dwordx4 v[160:163], v10, s[40:43], s8 offen offset:128 sc1
    v_mfma_f32_16x16x32_bf16 v[112:115], v[36:39], v[20:23], v[112:115]
    ds_read_b64_tr_b16 v[62:63], v3 offset:2336
    s_add_u32 s8, s8, s9
    s_waitcnt lgkmcnt(10)
    v_mfma_f32_16x16x32_bf16 v[108:111], v[40:43], v[140:143], v[108:111]
    ds_read_b64_tr_b16 v[64:65], v3 offset:9248
    v_cvt_pk_bf16_f32 v164, v100, v101
    v_cvt_pk_bf16_f32 v165, v102, v103
    v_mfma_f32_16x16x32_bf16 v[112:115], v[40:43], v[144:147], v[112:115]
    ds_read_b64_tr_b16 v[66:67], v3 offset:11552
    v_cvt_pk_bf16_f32 v168, v104, v105
    v_cvt_pk_bf16_f32 v169, v106, v107
    s_waitcnt lgkmcnt(10)
    v_mfma_f32_16x16x32_bf16 v[116:119], v[44:47], v[16:19], v[116:119]
    v_mfma_f32_16x16x32_bf16 v[120:123], v[44:47], v[20:23], v[120:123]
    s_waitcnt lgkmcnt(8)
    v_mfma_f32_16x16x32_bf16 v[116:119], v[48:51], v[140:143], v[116:119]
    v_cvt_pk_bf16_f32 v166, v108, v109
    v_cvt_pk_bf16_f32 v167, v110, v111
    v_mfma_f32_16x16x32_bf16 v[120:123], v[48:51], v[144:147], v[120:123]
    buffer_store_dwordx4 v[164:167], v10, s[40:43], s8 offen offset:0 sc1
    v_cvt_pk_bf16_f32 v170, v112, v113
    s_waitcnt lgkmcnt(6)
    v_mfma_f32_16x16x32_bf16 v[124:127], v[52:55], v[16:19], v[124:127]
    v_cvt_pk_bf16_f32 v171, v114, v115
    buffer_store_dwordx4 v[168:171], v10, s[40:43], s8 offen offset:128 sc1
    v_mfma_f32_16x16x32_bf16 v[128:131], v[52:55], v[20:23], v[128:131]
    s_add_u32 s8, s8, s9
    s_waitcnt lgkmcnt(4)
    v_mfma_f32_16x16x32_bf16 v[124:127], v[56:59], v[140:143], v[124:127]
    v_cvt_pk_bf16_f32 v172, v116, v117
    v_cvt_pk_bf16_f32 v173, v118, v119
    v_mfma_f32_16x16x32_bf16 v[128:131], v[56:59], v[144:147], v[128:131]
    v_cvt_pk_bf16_f32 v176, v120, v121
    v_cvt_pk_bf16_f32 v177, v122, v123
    s_waitcnt lgkmcnt(2)
    v_mfma_f32_16x16x32_bf16 v[132:135], v[60:63], v[16:19], v[132:135]
    v_mfma_f32_16x16x32_bf16 v[136:139], v[60:63], v[20:23], v[136:139]
    s_waitcnt lgkmcnt(0)
    v_mfma_f32_16x16x32_bf16 v[132:135], v[64:67], v[140:143], v[132:135]
    v_cvt_pk_bf16_f32 v174, v124, v125
    v_cvt_pk_bf16_f32 v175, v126, v127
    v_mfma_f32_16x16x32_bf16 v[136:139], v[64:67], v[144:147], v[136:139]
    buffer_store_dwordx4 v[172:175], v10, s[40:43], s8 offen offset:0 sc1
    v_cvt_pk_bf16_f32 v178, v128, v129
    v_cvt_pk_bf16_f32 v179, v130, v131
    buffer_store_dwordx4 v[176:179], v10, s[40:43], s8 offen offset:128 sc1
    s_nop 0
    v_cvt_pk_bf16_f32 v180, v132, v133
    v_cvt_pk_bf16_f32 v181, v134, v135
    s_nop 0
    v_cvt_pk_bf16_f32 v182, v136, v137
    v_cvt_pk_bf16_f32 v183, v138, v139
    buffer_store_dwordx4 v[180:183], v11, s[40:43], 0 offen sc1
    s_branch GC_POST
GC_V:
    v_lshl_add_u32 v2, v17, 3, v16
    v_add_u32 v6, 69632, v2
    s_lshl_b32 s9, s5, 6
    s_add_u32 s9, s9, s6
    s_mul_i32 s9, s9, 9216
    s_add_u32 s13, s9, 4718592
    v_mul_u32_u24 v16, 2304, v15
    v_lshl_add_u32 v10, v14, 4, v16
    s_getpc_b64 s[58:59]
    s_lshl_b32 s60, s3, 4
    v_add_u32 v12, s60, v1
    v_lshlrev_b32 v12, 7, v12
    s_mov_b32 exec_lo, 0xffff
    s_mov_b32 exec_hi, 0
    global_load_dword v13, v12, s[58:59]
    s_mov_b64 exec, -1
    s_barrier
    ds_read_b128 v[16:19], v4 offset:0
    ds_read_b128 v[20:23], v4 offset:2048
    ds_read_b64_tr_b16 v[32:33], v2 offset:0
    ds_read_b64_tr_b16 v[34:35], v2 offset:2304
    ds_read_b64_tr_b16 v[36:37], v2 offset:32
    ds_read_b64_tr_b16 v[38:39], v2 offset:2336
    ds_read_b64_tr_b16 v[40:41], v2 offset:64
    ds_read_b64_tr_b16 v[42:43], v2 offset:2368
    ds_read_b64_tr_b16 v[44:45], v2 offset:96
    ds_read_b64_tr_b16 v[46:47], v2 offset:2400
    ds_read_b64_tr_b16 v[48:49], v2 offset:128
    ds_read_b64_tr_b16 v[50:51], v2 offset:2432
    ds_read_b64_tr_b16 v[52:53], v2 offset:160
    ds_read_b64_tr_b16 v[54:55], v2 offset:2464
    s_waitcnt lgkmcnt(10)
    v_mfma_f32_16x16x32_bf16 v[68:71], v[16:19], v[32:35], 0
    ds_read_b64_tr_b16 v[56:57], v2 offset:192
    v_mfma_f32_16x16x32_bf16 v[72:75], v[20:23], v[32:35], 0
    ds_read_b64_tr_b16 v[58:59], v2 offset:2496
    s_waitcnt lgkmcnt(10)
    v_mfma_f32_16x16x32_bf16 v[76:79], v[16:19], v[36:39], 0
    ds_read_b64_tr_b16 v[60:61], v2 offset:224
    v_mfma_f32_16x16x32_bf16 v[80:83], v[20:23], v[36:39], 0
    ds_read_b64_tr_b16 v[62:63], v2 offset:2528
    s_waitcnt lgkmcnt(10)
    v_mfma_f32_16x16x32_bf16 v[84:87], v[16:19], v[40:43], 0
    ds_read_b64_tr_b16 v[64:65], v2 offset:256
    v_mfma_f32_16x16x32_bf16 v[88:91], v[20:23], v[40:43], 0
    ds_read_b64_tr_b16 v[66:67], v2 offset:2560
    s_waitcnt lgkmcnt(10)
    v_mfma_f32_16x16x32_bf16 v[92:95], v[16:19], v[44:47], 0
    ds_read_b128 v[24:27], v5 offset:0
    ds_read_b128 v[28:31], v5 offset:2048
    v_mfma_f32_16x16x32_bf16 v[96:99], v[20:23], v[44:47], 0
    ds_read_b64_tr_b16 v[32:33], v2 offset:9216
    ds_read_b64_tr_b16 v[34:35], v2 offset:11520
    s_waitcnt lgkmcnt(12)
    v_mfma_f32_16x16x32_bf16 v[100:103], v[16:19], v[48:51], 0
    ds_read_b64_tr_b16 v[36:37], v2 offset:9248
    v_mfma_f32_16x16x32_bf16 v[104:107], v[20:23], v[48:51], 0
    ds_read_b64_tr_b16 v[38:39], v2 offset:11552
    s_waitcnt lgkmcnt(12)
    v_mfma_f32_16x16x32_bf16 v[108:111], v[16:19], v[52:55], 0
    ds_read_b64_tr_b16 v[40:41], v2 offset:9280
    v_mfma_f32_16x16x32_bf16 v[112:115], v[20:23], v[52:55], 0
    ds_read_b64_tr_b16 v[42:43], v2 offset:11584
    s_waitcnt lgkmcnt(12)
    v_mfma_f32_16x16x32_bf16 v[116:119], v[16:19], v[56:59], 0
    ds_read_b64_tr_b16 v[44:45], v2 offset:9312
    v_mfma_f32_16x16x32_bf16 v[120:123], v[20:23], v[56:59], 0
    ds_read_b64_tr_b16 v[46:47], v2 offset:11616
    s_waitcnt lgkmcnt(12)
    v_mfma_f32_16x16x32_bf16 v[124:127], v[16:19], v[60:63], 0
    ds_read_b64_tr_b16 v[48:49], v2 offset:9344
    v_mfma_f32_16x16x32_bf16 v[128:131], v[20:23], v[60:63], 0
    ds_read_b64_tr_b16 v[50:51], v2 offset:11648
    s_waitcnt lgkmcnt(12)
    v_mfma_f32_16x16x32_bf16 v[132:135], v[16:19], v[64:67], 0
    ds_read_b64_tr_b16 v[52:53], v2 offset:9376
    v_mfma_f32_16x16x32_bf16 v[136:139], v[20:23], v[64:67], 0
    ds_read_b64_tr_b16 v[54:55], v2 offset:11680
    s_waitcnt lgkmcnt(10)
    v_mfma_f32_16x16x32_bf16 v[68:71], v[24:27], v[32:35], v[68:71]
    ds_read_b64_tr_b16 v[56:57], v2 offset:9408
    v_mfma_f32_16x16x32_bf16 v[72:75], v[28:31], v[32:35], v[72:75]
    ds_read_b64_tr_b16 v[58:59], v2 offset:11712
    s_waitcnt lgkmcnt(10)
    v_mfma_f32_16x16x32_bf16 v[76:79], v[24:27], v[36:39], v[76:79]
    ds_read_b64_tr_b16 v[60:61], v2 offset:9440
    v_mfma_f32_16x16x32_bf16 v[80:83], v[28:31], v[36:39], v[80:83]
    ds_read_b64_tr_b16 v[62:63], v2 offset:11744
    s_waitcnt lgkmcnt(10)
    v_mfma_f32_16x16x32_bf16 v[84:87], v[24:27], v[40:43], v[84:87]
    ds_read_b64_tr_b16 v[64:65], v2 offset:9472
    v_mfma_f32_16x16x32_bf16 v[88:91], v[28:31], v[40:43], v[88:91]
    ds_read_b64_tr_b16 v[66:67], v2 offset:11776
    s_barrier
    s_waitcnt lgkmcnt(10)
    v_mfma_f32_16x16x32_bf16 v[92:95], v[24:27], v[44:47], v[92:95]
    ds_read_b128 v[16:19], v4 offset:34816
    ds_read_b128 v[20:23], v4 offset:36864
    v_mfma_f32_16x16x32_bf16 v[96:99], v[28:31], v[44:47], v[96:99]
    ds_read_b64_tr_b16 v[32:33], v2 offset:34816
    ds_read_b64_tr_b16 v[34:35], v2 offset:37120
    s_waitcnt lgkmcnt(12)
    v_mfma_f32_16x16x32_bf16 v[100:103], v[24:27], v[48:51], v[100:103]
    ds_read_b64_tr_b16 v[36:37], v2 offset:34848
    v_mfma_f32_16x16x32_bf16 v[104:107], v[28:31], v[48:51], v[104:107]
    ds_read_b64_tr_b16 v[38:39], v2 offset:37152
    s_waitcnt lgkmcnt(12)
    v_mfma_f32_16x16x32_bf16 v[108:111], v[24:27], v[52:55], v[108:111]
    ds_read_b64_tr_b16 v[40:41], v2 offset:34880
    v_mfma_f32_16x16x32_bf16 v[112:115], v[28:31], v[52:55], v[112:115]
    ds_read_b64_tr_b16 v[42:43], v2 offset:37184
    s_waitcnt lgkmcnt(12)
    v_mfma_f32_16x16x32_bf16 v[116:119], v[24:27], v[56:59], v[116:119]
    ds_read_b64_tr_b16 v[44:45], v2 offset:34912
    v_mfma_f32_16x16x32_bf16 v[120:123], v[28:31], v[56:59], v[120:123]
    ds_read_b64_tr_b16 v[46:47], v2 offset:37216
    s_waitcnt lgkmcnt(12)
    v_mfma_f32_16x16x32_bf16 v[124:127], v[24:27], v[60:63], v[124:127]
    ds_read_b64_tr_b16 v[48:49], v2 offset:34944
    v_mfma_f32_16x16x32_bf16 v[128:131], v[28:31], v[60:63], v[128:131]
    ds_read_b64_tr_b16 v[50:51], v2 offset:37248
    s_waitcnt lgkmcnt(12)
    v_mfma_f32_16x16x32_bf16 v[132:135], v[24:27], v[64:67], v[132:135]
    ds_read_b64_tr_b16 v[52:53], v2 offset:34976
    v_mfma_f32_16x16x32_bf16 v[136:139], v[28:31], v[64:67], v[136:139]
    ds_read_b64_tr_b16 v[54:55], v2 offset:37280
    s_waitcnt lgkmcnt(10)
    v_mfma_f32_16x16x32_bf16 v[68:71], v[16:19], v[32:35], v[68:71]
    ds_read_b64_tr_b16 v[56:57], v2 offset:35008
    v_mfma_f32_16x16x32_bf16 v[72:75], v[20:23], v[32:35], v[72:75]
    ds_read_b64_tr_b16 v[58:59], v2 offset:37312
    s_waitcnt lgkmcnt(10)
    v_mfma_f32_16x16x32_bf16 v[76:79], v[16:19], v[36:39], v[76:79]
    ds_read_b64_tr_b16 v[60:61], v2 offset:35040
    v_mfma_f32_16x16x32_bf16 v[80:83], v[20:23], v[36:39], v[80:83]
    ds_read_b64_tr_b16 v[62:63], v2 offset:37344
    s_waitcnt lgkmcnt(10)
    v_mfma_f32_16x16x32_bf16 v[84:87], v[16:19], v[40:43], v[84:87]
    ds_read_b64_tr_b16 v[64:65], v2 offset:35072
    v_mfma_f32_16x16x32_bf16 v[88:91], v[20:23], v[40:43], v[88:91]
    ds_read_b64_tr_b16 v[66:67], v2 offset:37376
    s_waitcnt lgkmcnt(10)
    v_mfma_f32_16x16x32_bf16 v[92:95], v[16:19], v[44:47], v[92:95]
    ds_read_b128 v[24:27], v5 offset:34816
    ds_read_b128 v[28:31], v5 offset:36864
    v_mfma_f32_16x16x32_bf16 v[96:99], v[20:23], v[44:47], v[96:99]
    ds_read_b64_tr_b16 v[32:33], v2 offset:44032
    ds_read_b64_tr_b16 v[34:35], v2 offset:46336
    s_waitcnt lgkmcnt(12)
    v_mfma_f32_16x16x32_bf16 v[100:103], v[16:19], v[48:51], v[100:103]
    ds_read_b64_tr_b16 v[36:37], v2 offset:44064
    v_mfma_f32_16x16x32_bf16 v[104:107], v[20:23], v[48:51], v[104:107]
    ds_read_b64_tr_b16 v[38:39], v2 offset:46368
    s_waitcnt lgkmcnt(12)
    v_mfma_f32_16x16x32_bf16 v[108:111], v[16:19], v[52:55], v[108:111]
    ds_read_b64_tr_b16 v[40:41], v2 offset:44096
    v_mfma_f32_16x16x32_bf16 v[112:115], v[20:23], v[52:55], v[112:115]
    ds_read_b64_tr_b16 v[42:43], v2 offset:46400
    s_waitcnt lgkmcnt(12)
    v_mfma_f32_16x16x32_bf16 v[116:119], v[16:19], v[56:59], v[116:119]
    ds_read_b64_tr_b16 v[44:45], v2 offset:44128
    v_mfma_f32_16x16x32_bf16 v[120:123], v[20:23], v[56:59], v[120:123]
    ds_read_b64_tr_b16 v[46:47], v2 offset:46432
    s_waitcnt lgkmcnt(12)
    v_mfma_f32_16x16x32_bf16 v[124:127], v[16:19], v[60:63], v[124:127]
    ds_read_b64_tr_b16 v[48:49], v2 offset:44160
    v_mfma_f32_16x16x32_bf16 v[128:131], v[20:23], v[60:63], v[128:131]
    ds_read_b64_tr_b16 v[50:51], v2 offset:46464
    s_waitcnt lgkmcnt(12)
    v_mfma_f32_16x16x32_bf16 v[132:135], v[16:19], v[64:67], v[132:135]
    ds_read_b64_tr_b16 v[52:53], v2 offset:44192
    v_mfma_f32_16x16x32_bf16 v[136:139], v[20:23], v[64:67], v[136:139]
    ds_read_b64_tr_b16 v[54:55], v2 offset:46496
    s_waitcnt lgkmcnt(10)
    v_mfma_f32_16x16x32_bf16 v[68:71], v[24:27], v[32:35], v[68:71]
    ds_read_b64_tr_b16 v[56:57], v2 offset:44224
    v_mfma_f32_16x16x32_bf16 v[72:75], v[28:31], v[32:35], v[72:75]
    ds_read_b64_tr_b16 v[58:59], v2 offset:46528
    s_waitcnt lgkmcnt(10)
    v_mfma_f32_16x16x32_bf16 v[76:79], v[24:27], v[36:39], v[76:79]
    ds_read_b64_tr_b16 v[60:61], v2 offset:44256
    v_mfma_f32_16x16x32_bf16 v[80:83], v[28:31], v[36:39], v[80:83]
    ds_read_b64_tr_b16 v[62:63], v2 offset:46560
    s_waitcnt lgkmcnt(10)
    v_mfma_f32_16x16x32_bf16 v[84:87], v[24:27], v[40:43], v[84:87]
    ds_read_b64_tr_b16 v[64:65], v2 offset:44288
    v_mfma_f32_16x16x32_bf16 v[88:91], v[28:31], v[40:43], v[88:91]
    ds_read_b64_tr_b16 v[66:67], v2 offset:46592
    s_barrier
    s_waitcnt lgkmcnt(10)
    v_mfma_f32_16x16x32_bf16 v[92:95], v[24:27], v[44:47], v[92:95]
    ds_read_b128 v[16:19], v8 offset:0
    ds_read_b128 v[20:23], v8 offset:2048
    v_mfma_f32_16x16x32_bf16 v[96:99], v[28:31], v[44:47], v[96:99]
    ds_read_b64_tr_b16 v[32:33], v6 offset:0
    ds_read_b64_tr_b16 v[34:35], v6 offset:2304
    s_waitcnt lgkmcnt(12)
    v_mfma_f32_16x16x32_bf16 v[100:103], v[24:27], v[48:51], v[100:103]
    ds_read_b64_tr_b16 v[36:37], v6 offset:32
    v_mfma_f32_16x16x32_bf16 v[104:107], v[28:31], v[48:51], v[104:107]
    ds_read_b64_tr_b16 v[38:39], v6 offset:2336
    s_waitcnt lgkmcnt(12)
    v_mfma_f32_16x16x32_bf16 v[108:111], v[24:27], v[52:55], v[108:111]
    ds_read_b64_tr_b16 v[40:41], v6 offset:64
    v_mfma_f32_16x16x32_bf16 v[112:115], v[28:31], v[52:55], v[112:115]
    ds_read_b64_tr_b16 v[42:43], v6 offset:2368
    s_waitcnt lgkmcnt(12)
    v_mfma_f32_16x16x32_bf16 v[116:119], v[24:27], v[56:59], v[116:119]
    ds_read_b64_tr_b16 v[44:45], v6 offset:96
    v_mfma_f32_16x16x32_bf16 v[120:123], v[28:31], v[56:59], v[120:123]
    ds_read_b64_tr_b16 v[46:47], v6 offset:2400
    s_waitcnt lgkmcnt(12)
    v_mfma_f32_16x16x32_bf16 v[124:127], v[24:27], v[60:63], v[124:127]
    ds_read_b64_tr_b16 v[48:49], v6 offset:128
    v_mfma_f32_16x16x32_bf16 v[128:131], v[28:31], v[60:63], v[128:131]
    ds_read_b64_tr_b16 v[50:51], v6 offset:2432
    s_waitcnt lgkmcnt(12)
    v_mfma_f32_16x16x32_bf16 v[132:135], v[24:27], v[64:67], v[132:135]
    ds_read_b64_tr_b16 v[52:53], v6 offset:160
    v_mfma_f32_16x16x32_bf16 v[136:139], v[28:31], v[64:67], v[136:139]
    ds_read_b64_tr_b16 v[54:55], v6 offset:2464
    s_waitcnt lgkmcnt(10)
    v_mfma_f32_16x16x32_bf16 v[68:71], v[16:19], v[32:35], v[68:71]
    ds_read_b64_tr_b16 v[56:57], v6 offset:192
    v_mfma_f32_16x16x32_bf16 v[72:75], v[20:23], v[32:35], v[72:75]
    ds_read_b64_tr_b16 v[58:59], v6 offset:2496
    s_waitcnt lgkmcnt(10)
    v_mfma_f32_16x16x32_bf16 v[76:79], v[16:19], v[36:39], v[76:79]
    ds_read_b64_tr_b16 v[60:61], v6 offset:224
    v_mfma_f32_16x16x32_bf16 v[80:83], v[20:23], v[36:39], v[80:83]
    ds_read_b64_tr_b16 v[62:63], v6 offset:2528
    s_waitcnt lgkmcnt(10)
    v_mfma_f32_16x16x32_bf16 v[84:87], v[16:19], v[40:43], v[84:87]
    ds_read_b64_tr_b16 v[64:65], v6 offset:256
    v_mfma_f32_16x16x32_bf16 v[88:91], v[20:23], v[40:43], v[88:91]
    ds_read_b64_tr_b16 v[66:67], v6 offset:2560
    s_waitcnt lgkmcnt(10)
    v_mfma_f32_16x16x32_bf16 v[92:95], v[16:19], v[44:47], v[92:95]
    ds_read_b128 v[24:27], v9 offset:0
    ds_read_b128 v[28:31], v9 offset:2048
    v_mfma_f32_16x16x32_bf16 v[96:99], v[20:23], v[44:47], v[96:99]
    ds_read_b64_tr_b16 v[32:33], v6 offset:9216
    ds_read_b64_tr_b16 v[34:35], v6 offset:11520
    s_waitcnt lgkmcnt(12)
    v_mfma_f32_16x16x32_bf16 v[100:103], v[16:19], v[48:51], v[100:103]
    ds_read_b64_tr_b16 v[36:37], v6 offset:9248
    v_mfma_f32_16x16x32_bf16 v[104:107], v[20:23], v[48:51], v[104:107]
    ds_read_b64_tr_b16 v[38:39], v6 offset:11552
    s_waitcnt lgkmcnt(12)
    v_mfma_f32_16x16x32_bf16 v[108:111], v[16:19], v[52:55], v[108:111]
    ds_read_b64_tr_b16 v[40:41], v6 offset:9280
    v_mfma_f32_16x16x32_bf16 v[112:115], v[20:23], v[52:55], v[112:115]
    ds_read_b64_tr_b16 v[42:43], v6 offset:11584
    s_waitcnt lgkmcnt(12)
    v_mfma_f32_16x16x32_bf16 v[116:119], v[16:19], v[56:59], v[116:119]
    ds_read_b64_tr_b16 v[44:45], v6 offset:9312
    v_mfma_f32_16x16x32_bf16 v[120:123], v[20:23], v[56:59], v[120:123]
    ds_read_b64_tr_b16 v[46:47], v6 offset:11616
    s_waitcnt lgkmcnt(12)
    v_mfma_f32_16x16x32_bf16 v[124:127], v[16:19], v[60:63], v[124:127]
    ds_read_b64_tr_b16 v[48:49], v6 offset:9344
    v_mfma_f32_16x16x32_bf16 v[128:131], v[20:23], v[60:63], v[128:131]
    ds_read_b64_tr_b16 v[50:51], v6 offset:11648
    s_waitcnt lgkmcnt(12)
    v_mfma_f32_16x16x32_bf16 v[132:135], v[16:19], v[64:67], v[132:135]
    ds_read_b64_tr_b16 v[52:53], v6 offset:9376
    v_mfma_f32_16x16x32_bf16 v[136:139], v[20:23], v[64:67], v[136:139]
    ds_read_b64_tr_b16 v[54:55], v6 offset:11680
    s_waitcnt lgkmcnt(10)
    v_mfma_f32_16x16x32_bf16 v[68:71], v[24:27], v[32:35], v[68:71]
    ds_read_b64_tr_b16 v[56:57], v6 offset:9408
    v_mfma_f32_16x16x32_bf16 v[72:75], v[28:31], v[32:35], v[72:75]
    ds_read_b64_tr_b16 v[58:59], v6 offset:11712
    s_waitcnt lgkmcnt(10)
    v_mfma_f32_16x16x32_bf16 v[76:79], v[24:27], v[36:39], v[76:79]
    ds_read_b64_tr_b16 v[60:61], v6 offset:9440
    v_mfma_f32_16x16x32_bf16 v[80:83], v[28:31], v[36:39], v[80:83]
    ds_read_b64_tr_b16 v[62:63], v6 offset:11744
    s_waitcnt lgkmcnt(10)
    v_mfma_f32_16x16x32_bf16 v[84:87], v[24:27], v[40:43], v[84:87]
    ds_read_b64_tr_b16 v[64:65], v6 offset:9472
    v_mfma_f32_16x16x32_bf16 v[88:91], v[28:31], v[40:43], v[88:91]
    ds_read_b64_tr_b16 v[66:67], v6 offset:11776
    s_barrier
    s_waitcnt lgkmcnt(10)
    v_mfma_f32_16x16x32_bf16 v[92:95], v[24:27], v[44:47], v[92:95]
    ds_read_b128 v[16:19], v8 offset:34816
    ds_read_b128 v[20:23], v8 offset:36864
    v_mfma_f32_16x16x32_bf16 v[96:99], v[28:31], v[44:47], v[96:99]
    ds_read_b64_tr_b16 v[32:33], v6 offset:34816
    ds_read_b64_tr_b16 v[34:35], v6 offset:37120
    s_waitcnt lgkmcnt(12)
    v_mfma_f32_16x16x32_bf16 v[100:103], v[24:27], v[48:51], v[100:103]
    ds_read_b64_tr_b16 v[36:37], v6 offset:34848
    v_mfma_f32_16x16x32_bf16 v[104:107], v[28:31], v[48:51], v[104:107]
    ds_read_b64_tr_b16 v[38:39], v6 offset:37152
    s_waitcnt lgkmcnt(12)
    v_mfma_f32_16x16x32_bf16 v[108:111], v[24:27], v[52:55], v[108:111]
    ds_read_b64_tr_b16 v[40:41], v6 offset:34880
    v_mfma_f32_16x16x32_bf16 v[112:115], v[28:31], v[52:55], v[112:115]
    ds_read_b64_tr_b16 v[42:43], v6 offset:37184
    s_waitcnt lgkmcnt(12)
    v_mfma_f32_16x16x32_bf16 v[116:119], v[24:27], v[56:59], v[116:119]
    ds_read_b64_tr_b16 v[44:45], v6 offset:34912
    v_mfma_f32_16x16x32_bf16 v[120:123], v[28:31], v[56:59], v[120:123]
    ds_read_b64_tr_b16 v[46:47], v6 offset:37216
    s_waitcnt lgkmcnt(12)
    v_mfma_f32_16x16x32_bf16 v[124:127], v[24:27], v[60:63], v[124:127]
    ds_read_b64_tr_b16 v[48:49], v6 offset:34944
    v_mfma_f32_16x16x32_bf16 v[128:131], v[28:31], v[60:63], v[128:131]
    ds_read_b64_tr_b16 v[50:51], v6 offset:37248
    s_waitcnt lgkmcnt(12)
    v_mfma_f32_16x16x32_bf16 v[132:135], v[24:27], v[64:67], v[132:135]
    ds_read_b64_tr_b16 v[52:53], v6 offset:34976
    v_mfma_f32_16x16x32_bf16 v[136:139], v[28:31], v[64:67], v[136:139]
    ds_read_b64_tr_b16 v[54:55], v6 offset:37280
    s_waitcnt lgkmcnt(10)
    v_mfma_f32_16x16x32_bf16 v[68:71], v[16:19], v[32:35], v[68:71]
    ds_read_b64_tr_b16 v[56:57], v6 offset:35008
    v_mfma_f32_16x16x32_bf16 v[72:75], v[20:23], v[32:35], v[72:75]
    ds_read_b64_tr_b16 v[58:59], v6 offset:37312
    s_waitcnt lgkmcnt(10)
    v_mfma_f32_16x16x32_bf16 v[76:79], v[16:19], v[36:39], v[76:79]
    ds_read_b64_tr_b16 v[60:61], v6 offset:35040
    v_mfma_f32_16x16x32_bf16 v[80:83], v[20:23], v[36:39], v[80:83]
    ds_read_b64_tr_b16 v[62:63], v6 offset:37344
    s_waitcnt lgkmcnt(10)
    v_mfma_f32_16x16x32_bf16 v[84:87], v[16:19], v[40:43], v[84:87]
    ds_read_b64_tr_b16 v[64:65], v6 offset:35072
    v_mfma_f32_16x16x32_bf16 v[88:91], v[20:23], v[40:43], v[88:91]
    ds_read_b64_tr_b16 v[66:67], v6 offset:37376
    s_waitcnt lgkmcnt(10)
    v_mfma_f32_16x16x32_bf16 v[92:95], v[16:19], v[44:47], v[92:95]
    ds_read_b128 v[24:27], v9 offset:34816
    ds_read_b128 v[28:31], v9 offset:36864
    v_mfma_f32_16x16x32_bf16 v[96:99], v[20:23], v[44:47], v[96:99]
    ds_read_b64_tr_b16 v[32:33], v6 offset:44032
    ds_read_b64_tr_b16 v[34:35], v6 offset:46336
    s_waitcnt lgkmcnt(12)
    v_mfma_f32_16x16x32_bf16 v[100:103], v[16:19], v[48:51], v[100:103]
    ds_read_b64_tr_b16 v[36:37], v6 offset:44064
    v_mfma_f32_16x16x32_bf16 v[104:107], v[20:23], v[48:51], v[104:107]
    ds_read_b64_tr_b16 v[38:39], v6 offset:46368
    s_waitcnt lgkmcnt(12)
    v_mfma_f32_16x16x32_bf16 v[108:111], v[16:19], v[52:55], v[108:111]
    ds_read_b64_tr_b16 v[40:41], v6 offset:44096
    v_mfma_f32_16x16x32_bf16 v[112:115], v[20:23], v[52:55], v[112:115]
    ds_read_b64_tr_b16 v[42:43], v6 offset:46400
    s_waitcnt lgkmcnt(12)
    v_mfma_f32_16x16x32_bf16 v[116:119], v[16:19], v[56:59], v[116:119]
    ds_read_b64_tr_b16 v[44:45], v6 offset:44128
    v_mfma_f32_16x16x32_bf16 v[120:123], v[20:23], v[56:59], v[120:123]
    ds_read_b64_tr_b16 v[46:47], v6 offset:46432
    s_waitcnt lgkmcnt(12)
    v_mfma_f32_16x16x32_bf16 v[124:127], v[16:19], v[60:63], v[124:127]
    ds_read_b64_tr_b16 v[48:49], v6 offset:44160
    v_mfma_f32_16x16x32_bf16 v[128:131], v[20:23], v[60:63], v[128:131]
    ds_read_b64_tr_b16 v[50:51], v6 offset:46464
    s_waitcnt lgkmcnt(12)
    v_mfma_f32_16x16x32_bf16 v[132:135], v[16:19], v[64:67], v[132:135]
    ds_read_b64_tr_b16 v[52:53], v6 offset:44192
    v_mfma_f32_16x16x32_bf16 v[136:139], v[20:23], v[64:67], v[136:139]
    ds_read_b64_tr_b16 v[54:55], v6 offset:46496
    s_waitcnt lgkmcnt(10)
    v_mfma_f32_16x16x32_bf16 v[68:71], v[24:27], v[32:35], v[68:71]
    ds_read_b64_tr_b16 v[56:57], v6 offset:44224
    v_mfma_f32_16x16x32_bf16 v[72:75], v[28:31], v[32:35], v[72:75]
    ds_read_b64_tr_b16 v[58:59], v6 offset:46528
    s_waitcnt lgkmcnt(10)
    v_mfma_f32_16x16x32_bf16 v[76:79], v[24:27], v[36:39], v[76:79]
    ds_read_b64_tr_b16 v[60:61], v6 offset:44256
    v_mfma_f32_16x16x32_bf16 v[80:83], v[28:31], v[36:39], v[80:83]
    ds_read_b64_tr_b16 v[62:63], v6 offset:46560
    s_waitcnt lgkmcnt(10)
    v_mfma_f32_16x16x32_bf16 v[84:87], v[24:27], v[40:43], v[84:87]
    ds_read_b64_tr_b16 v[64:65], v6 offset:44288
    v_mfma_f32_16x16x32_bf16 v[88:91], v[28:31], v[40:43], v[88:91]
    ds_read_b64_tr_b16 v[66:67], v6 offset:46592
    s_barrier
    s_waitcnt lgkmcnt(10)
    v_mfma_f32_16x16x32_bf16 v[92:95], v[24:27], v[44:47], v[92:95]
    ds_read_b128 v[16:19], v4 offset:0
    ds_read_b128 v[20:23], v4 offset:2048
    v_mfma_f32_16x16x32_bf16 v[96:99], v[28:31], v[44:47], v[96:99]
    ds_read_b64_tr_b16 v[32:33], v2 offset:0
    ds_read_b64_tr_b16 v[34:35], v2 offset:2304
    s_waitcnt lgkmcnt(12)
    v_mfma_f32_16x16x32_bf16 v[100:103], v[24:27], v[48:51], v[100:103]
    ds_read_b64_tr_b16 v[36:37], v2 offset:32
    v_mfma_f32_16x16x32_bf16 v[104:107], v[28:31], v[48:51], v[104:107]
    ds_read_b64_tr_b16 v[38:39], v2 offset:2336
    s_waitcnt lgkmcnt(12)
    v_mfma_f32_16x16x32_bf16 v[108:111], v[24:27], v[52:55], v[108:111]
    ds_read_b64_tr_b16 v[40:41], v2 offset:64
    v_mfma_f32_16x16x32_bf16 v[112:115], v[28:31], v[52:55], v[112:115]
    ds_read_b64_tr_b16 v[42:43], v2 offset:2368
    s_waitcnt lgkmcnt(12)
    v_mfma_f32_16x16x32_bf16 v[116:119], v[24:27], v[56:59], v[116:119]
    ds_read_b64_tr_b16 v[44:45], v2 offset:96
    v_mfma_f32_16x16x32_bf16 v[120:123], v[28:31], v[56:59], v[120:123]
    ds_read_b64_tr_b16 v[46:47], v2 offset:2400
    s_waitcnt lgkmcnt(12)
    v_mfma_f32_16x16x32_bf16 v[124:127], v[24:27], v[60:63], v[124:127]
    ds_read_b64_tr_b16 v[48:49], v2 offset:128
    v_mfma_f32_16x16x32_bf16 v[128:131], v[28:31], v[60:63], v[128:131]
    ds_read_b64_tr_b16 v[50:51], v2 offset:2432
    s_waitcnt lgkmcnt(12)
    v_mfma_f32_16x16x32_bf16 v[132:135], v[24:27], v[64:67], v[132:135]
    ds_read_b64_tr_b16 v[52:53], v2 offset:160
    v_mfma_f32_16x16x32_bf16 v[136:139], v[28:31], v[64:67], v[136:139]
    ds_read_b64_tr_b16 v[54:55], v2 offset:2464
    s_waitcnt lgkmcnt(10)
    v_mfma_f32_16x16x32_bf16 v[68:71], v[16:19], v[32:35], v[68:71]
    ds_read_b64_tr_b16 v[56:57], v2 offset:192
    v_mfma_f32_16x16x32_bf16 v[72:75], v[20:23], v[32:35], v[72:75]
    ds_read_b64_tr_b16 v[58:59], v2 offset:2496
    s_waitcnt lgkmcnt(10)
    v_mfma_f32_16x16x32_bf16 v[76:79], v[16:19], v[36:39], v[76:79]
    ds_read_b64_tr_b16 v[60:61], v2 offset:224
    v_mfma_f32_16x16x32_bf16 v[80:83], v[20:23], v[36:39], v[80:83]
    ds_read_b64_tr_b16 v[62:63], v2 offset:2528
    s_waitcnt lgkmcnt(10)
    v_mfma_f32_16x16x32_bf16 v[84:87], v[16:19], v[40:43], v[84:87]
    ds_read_b64_tr_b16 v[64:65], v2 offset:256
    v_mfma_f32_16x16x32_bf16 v[88:91], v[20:23], v[40:43], v[88:91]
    ds_read_b64_tr_b16 v[66:67], v2 offset:2560
    s_waitcnt lgkmcnt(10)
    v_mfma_f32_16x16x32_bf16 v[92:95], v[16:19], v[44:47], v[92:95]
    ds_read_b128 v[24:27], v5 offset:0
    ds_read_b128 v[28:31], v5 offset:2048
    v_mfma_f32_16x16x32_bf16 v[96:99], v[20:23], v[44:47], v[96:99]
    ds_read_b64_tr_b16 v[32:33], v2 offset:9216
    ds_read_b64_tr_b16 v[34:35], v2 offset:11520
    s_waitcnt lgkmcnt(12)
    v_mfma_f32_16x16x32_bf16 v[100:103], v[16:19], v[48:51], v[100:103]
    ds_read_b64_tr_b16 v[36:37], v2 offset:9248
    v_mfma_f32_16x16x32_bf16 v[104:107], v[20:23], v[48:51], v[104:107]
    ds_read_b64_tr_b16 v[38:39], v2 offset:11552
    s_waitcnt lgkmcnt(12)
    v_mfma_f32_16x16x32_bf16 v[108:111], v[16:19], v[52:55], v[108:111]
    ds_read_b64_tr_b16 v[40:41], v2 offset:9280
    v_mfma_f32_16x16x32_bf16 v[112:115], v[20:23], v[52:55], v[112:115]
    ds_read_b64_tr_b16 v[42:43], v2 offset:11584
    s_waitcnt lgkmcnt(12)
    v_mfma_f32_16x16x32_bf16 v[116:119], v[16:19], v[56:59], v[116:119]
    ds_read_b64_tr_b16 v[44:45], v2 offset:9312
    v_mfma_f32_16x16x32_bf16 v[120:123], v[20:23], v[56:59], v[120:123]
    ds_read_b64_tr_b16 v[46:47], v2 offset:11616
    s_waitcnt lgkmcnt(12)
    v_mfma_f32_16x16x32_bf16 v[124:127], v[16:19], v[60:63], v[124:127]
    ds_read_b64_tr_b16 v[48:49], v2 offset:9344
    v_mfma_f32_16x16x32_bf16 v[128:131], v[20:23], v[60:63], v[128:131]
    ds_read_b64_tr_b16 v[50:51], v2 offset:11648
    s_waitcnt lgkmcnt(12)
    buffer_load_dwordx2 v[236:237], v238, s[52:55], 0 offen sc1
    v_mfma_f32_16x16x32_bf16 v[132:135], v[16:19], v[64:67], v[132:135]
    ds_read_b64_tr_b16 v[52:53], v2 offset:9376
    v_mfma_f32_16x16x32_bf16 v[136:139], v[20:23], v[64:67], v[136:139]
    ds_read_b64_tr_b16 v[54:55], v2 offset:11680
    s_waitcnt lgkmcnt(10)
    v_mfma_f32_16x16x32_bf16 v[68:71], v[24:27], v[32:35], v[68:71]
    ds_read_b64_tr_b16 v[56:57], v2 offset:9408
    v_mfma_f32_16x16x32_bf16 v[72:75], v[28:31], v[32:35], v[72:75]
    ds_read_b64_tr_b16 v[58:59], v2 offset:11712
    s_waitcnt lgkmcnt(10)
    v_mfma_f32_16x16x32_bf16 v[76:79], v[24:27], v[36:39], v[76:79]
    ds_read_b64_tr_b16 v[60:61], v2 offset:9440
    v_mfma_f32_16x16x32_bf16 v[80:83], v[28:31], v[36:39], v[80:83]
    ds_read_b64_tr_b16 v[62:63], v2 offset:11744
    s_waitcnt lgkmcnt(10)
    v_mfma_f32_16x16x32_bf16 v[84:87], v[24:27], v[40:43], v[84:87]
    ds_read_b64_tr_b16 v[64:65], v2 offset:9472
    v_mfma_f32_16x16x32_bf16 v[88:91], v[28:31], v[40:43], v[88:91]
    ds_read_b64_tr_b16 v[66:67], v2 offset:11776
    s_barrier
    s_waitcnt lgkmcnt(10)
    v_mfma_f32_16x16x32_bf16 v[92:95], v[24:27], v[44:47], v[92:95]
    ds_read_b128 v[16:19], v4 offset:34816
    ds_read_b128 v[20:23], v4 offset:36864
    v_mfma_f32_16x16x32_bf16 v[96:99], v[28:31], v[44:47], v[96:99]
    ds_read_b64_tr_b16 v[32:33], v2 offset:34816
    ds_read_b64_tr_b16 v[34:35], v2 offset:37120
    s_waitcnt lgkmcnt(12)
    v_mfma_f32_16x16x32_bf16 v[100:103], v[24:27], v[48:51], v[100:103]
    ds_read_b64_tr_b16 v[36:37], v2 offset:34848
    v_mfma_f32_16x16x32_bf16 v[104:107], v[28:31], v[48:51], v[104:107]
    ds_read_b64_tr_b16 v[38:39], v2 offset:37152
    s_waitcnt lgkmcnt(12)
    v_mfma_f32_16x16x32_bf16 v[108:111], v[24:27], v[52:55], v[108:111]
    ds_read_b64_tr_b16 v[40:41], v2 offset:34880
    v_mfma_f32_16x16x32_bf16 v[112:115], v[28:31], v[52:55], v[112:115]
    ds_read_b64_tr_b16 v[42:43], v2 offset:37184
    s_waitcnt lgkmcnt(12)
    v_mfma_f32_16x16x32_bf16 v[116:119], v[24:27], v[56:59], v[116:119]
    ds_read_b64_tr_b16 v[44:45], v2 offset:34912
    v_mfma_f32_16x16x32_bf16 v[120:123], v[28:31], v[56:59], v[120:123]
    ds_read_b64_tr_b16 v[46:47], v2 offset:37216
    s_waitcnt lgkmcnt(12)
    v_mfma_f32_16x16x32_bf16 v[124:127], v[24:27], v[60:63], v[124:127]
    ds_read_b64_tr_b16 v[48:49], v2 offset:34944
    v_mfma_f32_16x16x32_bf16 v[128:131], v[28:31], v[60:63], v[128:131]
    ds_read_b64_tr_b16 v[50:51], v2 offset:37248
    s_waitcnt lgkmcnt(12)
    v_mfma_f32_16x16x32_bf16 v[132:135], v[24:27], v[64:67], v[132:135]
    ds_read_b64_tr_b16 v[52:53], v2 offset:34976
    v_mfma_f32_16x16x32_bf16 v[136:139], v[28:31], v[64:67], v[136:139]
    ds_read_b64_tr_b16 v[54:55], v2 offset:37280
    s_waitcnt lgkmcnt(10)
    v_mfma_f32_16x16x32_bf16 v[68:71], v[16:19], v[32:35], v[68:71]
    ds_read_b64_tr_b16 v[56:57], v2 offset:35008
    v_mfma_f32_16x16x32_bf16 v[72:75], v[20:23], v[32:35], v[72:75]
    ds_read_b64_tr_b16 v[58:59], v2 offset:37312
    s_waitcnt lgkmcnt(10)
    v_mfma_f32_16x16x32_bf16 v[76:79], v[16:19], v[36:39], v[76:79]
    ds_read_b64_tr_b16 v[60:61], v2 offset:35040
    v_mfma_f32_16x16x32_bf16 v[80:83], v[20:23], v[36:39], v[80:83]
    ds_read_b64_tr_b16 v[62:63], v2 offset:37344
    s_waitcnt lgkmcnt(10)
    v_mfma_f32_16x16x32_bf16 v[84:87], v[16:19], v[40:43], v[84:87]
    ds_read_b64_tr_b16 v[64:65], v2 offset:35072
    v_mfma_f32_16x16x32_bf16 v[88:91], v[20:23], v[40:43], v[88:91]
    ds_read_b64_tr_b16 v[66:67], v2 offset:37376
    s_waitcnt lgkmcnt(10)
    v_mfma_f32_16x16x32_bf16 v[92:95], v[16:19], v[44:47], v[92:95]
    ds_read_b128 v[24:27], v5 offset:34816
    ds_read_b128 v[28:31], v5 offset:36864
    v_mfma_f32_16x16x32_bf16 v[96:99], v[20:23], v[44:47], v[96:99]
    ds_read_b64_tr_b16 v[32:33], v2 offset:44032
    ds_read_b64_tr_b16 v[34:35], v2 offset:46336
    s_waitcnt lgkmcnt(12)
    v_mfma_f32_16x16x32_bf16 v[100:103], v[16:19], v[48:51], v[100:103]
    ds_read_b64_tr_b16 v[36:37], v2 offset:44064
    v_mfma_f32_16x16x32_bf16 v[104:107], v[20:23], v[48:51], v[104:107]
    ds_read_b64_tr_b16 v[38:39], v2 offset:46368
    s_waitcnt lgkmcnt(12)
    v_mfma_f32_16x16x32_bf16 v[108:111], v[16:19], v[52:55], v[108:111]
    ds_read_b64_tr_b16 v[40:41], v2 offset:44096
    v_mfma_f32_16x16x32_bf16 v[112:115], v[20:23], v[52:55], v[112:115]
    ds_read_b64_tr_b16 v[42:43], v2 offset:46400
    s_waitcnt lgkmcnt(12)
    v_mfma_f32_16x16x32_bf16 v[116:119], v[16:19], v[56:59], v[116:119]
    ds_read_b64_tr_b16 v[44:45], v2 offset:44128
    v_mfma_f32_16x16x32_bf16 v[120:123], v[20:23], v[56:59], v[120:123]
    ds_read_b64_tr_b16 v[46:47], v2 offset:46432
    s_waitcnt lgkmcnt(12)
    v_mfma_f32_16x16x32_bf16 v[124:127], v[16:19], v[60:63], v[124:127]
    ds_read_b64_tr_b16 v[48:49], v2 offset:44160
    v_mfma_f32_16x16x32_bf16 v[128:131], v[20:23], v[60:63], v[128:131]
    ds_read_b64_tr_b16 v[50:51], v2 offset:46464
    s_waitcnt lgkmcnt(12)
    v_mfma_f32_16x16x32_bf16 v[132:135], v[16:19], v[64:67], v[132:135]
    ds_read_b64_tr_b16 v[52:53], v2 offset:44192
    v_mfma_f32_16x16x32_bf16 v[136:139], v[20:23], v[64:67], v[136:139]
    ds_read_b64_tr_b16 v[54:55], v2 offset:46496
    s_waitcnt lgkmcnt(10)
    v_mfma_f32_16x16x32_bf16 v[68:71], v[24:27], v[32:35], v[68:71]
    ds_read_b64_tr_b16 v[56:57], v2 offset:44224
    v_mfma_f32_16x16x32_bf16 v[72:75], v[28:31], v[32:35], v[72:75]
    ds_read_b64_tr_b16 v[58:59], v2 offset:46528
    s_waitcnt lgkmcnt(10)
    v_mfma_f32_16x16x32_bf16 v[76:79], v[24:27], v[36:39], v[76:79]
    ds_read_b64_tr_b16 v[60:61], v2 offset:44256
    v_mfma_f32_16x16x32_bf16 v[80:83], v[28:31], v[36:39], v[80:83]
    ds_read_b64_tr_b16 v[62:63], v2 offset:46560
    s_waitcnt lgkmcnt(10)
    v_mfma_f32_16x16x32_bf16 v[84:87], v[24:27], v[40:43], v[84:87]
    ds_read_b64_tr_b16 v[64:65], v2 offset:44288
    v_mfma_f32_16x16x32_bf16 v[88:91], v[28:31], v[40:43], v[88:91]
    ds_read_b64_tr_b16 v[66:67], v2 offset:46592
    s_barrier
    s_waitcnt lgkmcnt(10)
    v_mfma_f32_16x16x32_bf16 v[92:95], v[24:27], v[44:47], v[92:95]
    ds_read_b128 v[16:19], v8 offset:0
    ds_read_b128 v[20:23], v8 offset:2048
    v_mfma_f32_16x16x32_bf16 v[96:99], v[28:31], v[44:47], v[96:99]
    ds_read_b64_tr_b16 v[32:33], v6 offset:0
    ds_read_b64_tr_b16 v[34:35], v6 offset:2304
    s_waitcnt lgkmcnt(12)
    v_mfma_f32_16x16x32_bf16 v[100:103], v[24:27], v[48:51], v[100:103]
    ds_read_b64_tr_b16 v[36:37], v6 offset:32
    v_mfma_f32_16x16x32_bf16 v[104:107], v[28:31], v[48:51], v[104:107]
    ds_read_b64_tr_b16 v[38:39], v6 offset:2336
    s_waitcnt lgkmcnt(12)
    v_mfma_f32_16x16x32_bf16 v[108:111], v[24:27], v[52:55], v[108:111]
    ds_read_b64_tr_b16 v[40:41], v6 offset:64
    v_mfma_f32_16x16x32_bf16 v[112:115], v[28:31], v[52:55], v[112:115]
    ds_read_b64_tr_b16 v[42:43], v6 offset:2368
    s_waitcnt lgkmcnt(12)
    v_mfma_f32_16x16x32_bf16 v[116:119], v[24:27], v[56:59], v[116:119]
    ds_read_b64_tr_b16 v[44:45], v6 offset:96
    v_mfma_f32_16x16x32_bf16 v[120:123], v[28:31], v[56:59], v[120:123]
    ds_read_b64_tr_b16 v[46:47], v6 offset:2400
    s_waitcnt lgkmcnt(12)
    v_mfma_f32_16x16x32_bf16 v[124:127], v[24:27], v[60:63], v[124:127]
    ds_read_b64_tr_b16 v[48:49], v6 offset:128
    v_mfma_f32_16x16x32_bf16 v[128:131], v[28:31], v[60:63], v[128:131]
    ds_read_b64_tr_b16 v[50:51], v6 offset:2432
    s_waitcnt lgkmcnt(12)
    v_mfma_f32_16x16x32_bf16 v[132:135], v[24:27], v[64:67], v[132:135]
    ds_read_b64_tr_b16 v[52:53], v6 offset:160
    v_mfma_f32_16x16x32_bf16 v[136:139], v[28:31], v[64:67], v[136:139]
    ds_read_b64_tr_b16 v[54:55], v6 offset:2464
    s_waitcnt lgkmcnt(10)
    v_mfma_f32_16x16x32_bf16 v[68:71], v[16:19], v[32:35], v[68:71]
    ds_read_b64_tr_b16 v[56:57], v6 offset:192
    v_mfma_f32_16x16x32_bf16 v[72:75], v[20:23], v[32:35], v[72:75]
    ds_read_b64_tr_b16 v[58:59], v6 offset:2496
    s_waitcnt lgkmcnt(10)
    v_mfma_f32_16x16x32_bf16 v[76:79], v[16:19], v[36:39], v[76:79]
    ds_read_b64_tr_b16 v[60:61], v6 offset:224
    v_mfma_f32_16x16x32_bf16 v[80:83], v[20:23], v[36:39], v[80:83]
    ds_read_b64_tr_b16 v[62:63], v6 offset:2528
    s_waitcnt lgkmcnt(10)
    v_mfma_f32_16x16x32_bf16 v[84:87], v[16:19], v[40:43], v[84:87]
    ds_read_b64_tr_b16 v[64:65], v6 offset:256
    v_mfma_f32_16x16x32_bf16 v[88:91], v[20:23], v[40:43], v[88:91]
    ds_read_b64_tr_b16 v[66:67], v6 offset:2560
    s_waitcnt lgkmcnt(10)
    v_mfma_f32_16x16x32_bf16 v[92:95], v[16:19], v[44:47], v[92:95]
    ds_read_b128 v[24:27], v9 offset:0
    ds_read_b128 v[28:31], v9 offset:2048
    v_mfma_f32_16x16x32_bf16 v[96:99], v[20:23], v[44:47], v[96:99]
    ds_read_b64_tr_b16 v[32:33], v6 offset:9216
    ds_read_b64_tr_b16 v[34:35], v6 offset:11520
    s_waitcnt lgkmcnt(12)
    v_mfma_f32_16x16x32_bf16 v[100:103], v[16:19], v[48:51], v[100:103]
    ds_read_b64_tr_b16 v[36:37], v6 offset:9248
    v_mfma_f32_16x16x32_bf16 v[104:107], v[20:23], v[48:51], v[104:107]
    ds_read_b64_tr_b16 v[38:39], v6 offset:11552
    s_waitcnt lgkmcnt(12)
    v_mfma_f32_16x16x32_bf16 v[108:111], v[16:19], v[52:55], v[108:111]
    ds_read_b64_tr_b16 v[40:41], v6 offset:9280
    v_mfma_f32_16x16x32_bf16 v[112:115], v[20:23], v[52:55], v[112:115]
    ds_read_b64_tr_b16 v[42:43], v6 offset:11584
    s_waitcnt lgkmcnt(12)
    v_mfma_f32_16x16x32_bf16 v[116:119], v[16:19], v[56:59], v[116:119]
    ds_read_b64_tr_b16 v[44:45], v6 offset:9312
    v_mfma_f32_16x16x32_bf16 v[120:123], v[20:23], v[56:59], v[120:123]
    ds_read_b64_tr_b16 v[46:47], v6 offset:11616
    s_waitcnt lgkmcnt(12)
    v_mfma_f32_16x16x32_bf16 v[124:127], v[16:19], v[60:63], v[124:127]
    ds_read_b64_tr_b16 v[48:49], v6 offset:9344
    v_mfma_f32_16x16x32_bf16 v[128:131], v[20:23], v[60:63], v[128:131]
    ds_read_b64_tr_b16 v[50:51], v6 offset:11648
    s_waitcnt lgkmcnt(12)
    v_mfma_f32_16x16x32_bf16 v[132:135], v[16:19], v[64:67], v[132:135]
    ds_read_b64_tr_b16 v[52:53], v6 offset:9376
    v_mfma_f32_16x16x32_bf16 v[136:139], v[20:23], v[64:67], v[136:139]
    ds_read_b64_tr_b16 v[54:55], v6 offset:11680
    s_waitcnt lgkmcnt(10)
    v_mfma_f32_16x16x32_bf16 v[68:71], v[24:27], v[32:35], v[68:71]
    ds_read_b64_tr_b16 v[56:57], v6 offset:9408
    v_mfma_f32_16x16x32_bf16 v[72:75], v[28:31], v[32:35], v[72:75]
    ds_read_b64_tr_b16 v[58:59], v6 offset:11712
    s_waitcnt lgkmcnt(10)
    v_mfma_f32_16x16x32_bf16 v[76:79], v[24:27], v[36:39], v[76:79]
    ds_read_b64_tr_b16 v[60:61], v6 offset:9440
    v_mfma_f32_16x16x32_bf16 v[80:83], v[28:31], v[36:39], v[80:83]
    ds_read_b64_tr_b16 v[62:63], v6 offset:11744
    s_waitcnt lgkmcnt(10)
    v_mfma_f32_16x16x32_bf16 v[84:87], v[24:27], v[40:43], v[84:87]
    ds_read_b64_tr_b16 v[64:65], v6 offset:9472
    v_mfma_f32_16x16x32_bf16 v[88:91], v[28:31], v[40:43], v[88:91]
    ds_read_b64_tr_b16 v[66:67], v6 offset:11776
    s_barrier
    s_waitcnt lgkmcnt(10)
    v_mfma_f32_16x16x32_bf16 v[92:95], v[24:27], v[44:47], v[92:95]
    ds_read_b128 v[16:19], v8 offset:34816
    ds_read_b128 v[20:23], v8 offset:36864
    v_mfma_f32_16x16x32_bf16 v[96:99], v[28:31], v[44:47], v[96:99]
    ds_read_b64_tr_b16 v[32:33], v6 offset:34816
    ds_read_b64_tr_b16 v[34:35], v6 offset:37120
    s_waitcnt lgkmcnt(12)
    v_mfma_f32_16x16x32_bf16 v[100:103], v[24:27], v[48:51], v[100:103]
    ds_read_b64_tr_b16 v[36:37], v6 offset:34848
    v_mfma_f32_16x16x32_bf16 v[104:107], v[28:31], v[48:51], v[104:107]
    ds_read_b64_tr_b16 v[38:39], v6 offset:37152
    s_waitcnt lgkmcnt(12)
    v_mfma_f32_16x16x32_bf16 v[108:111], v[24:27], v[52:55], v[108:111]
    ds_read_b64_tr_b16 v[40:41], v6 offset:34880
    v_mfma_f32_16x16x32_bf16 v[112:115], v[28:31], v[52:55], v[112:115]
    ds_read_b64_tr_b16 v[42:43], v6 offset:37184
    s_waitcnt lgkmcnt(12)
    v_mfma_f32_16x16x32_bf16 v[116:119], v[24:27], v[56:59], v[116:119]
    ds_read_b64_tr_b16 v[44:45], v6 offset:34912
    v_mfma_f32_16x16x32_bf16 v[120:123], v[28:31], v[56:59], v[120:123]
    ds_read_b64_tr_b16 v[46:47], v6 offset:37216
    s_waitcnt lgkmcnt(12)
    v_mfma_f32_16x16x32_bf16 v[124:127], v[24:27], v[60:63], v[124:127]
    ds_read_b64_tr_b16 v[48:49], v6 offset:34944
    v_mfma_f32_16x16x32_bf16 v[128:131], v[28:31], v[60:63], v[128:131]
    ds_read_b64_tr_b16 v[50:51], v6 offset:37248
    s_waitcnt lgkmcnt(12)
    v_mfma_f32_16x16x32_bf16 v[132:135], v[24:27], v[64:67], v[132:135]
    ds_read_b64_tr_b16 v[52:53], v6 offset:34976
    v_mfma_f32_16x16x32_bf16 v[136:139], v[28:31], v[64:67], v[136:139]
    ds_read_b64_tr_b16 v[54:55], v6 offset:37280
    s_waitcnt lgkmcnt(10)
    v_mfma_f32_16x16x32_bf16 v[68:71], v[16:19], v[32:35], v[68:71]
    ds_read_b64_tr_b16 v[56:57], v6 offset:35008
    v_mfma_f32_16x16x32_bf16 v[72:75], v[20:23], v[32:35], v[72:75]
    ds_read_b64_tr_b16 v[58:59], v6 offset:37312
    s_waitcnt lgkmcnt(10)
    v_mfma_f32_16x16x32_bf16 v[76:79], v[16:19], v[36:39], v[76:79]
    ds_read_b64_tr_b16 v[60:61], v6 offset:35040
    v_mfma_f32_16x16x32_bf16 v[80:83], v[20:23], v[36:39], v[80:83]
    ds_read_b64_tr_b16 v[62:63], v6 offset:37344
    s_waitcnt lgkmcnt(10)
    v_mfma_f32_16x16x32_bf16 v[84:87], v[16:19], v[40:43], v[84:87]
    ds_read_b64_tr_b16 v[64:65], v6 offset:35072
    v_mfma_f32_16x16x32_bf16 v[88:91], v[20:23], v[40:43], v[88:91]
    ds_read_b64_tr_b16 v[66:67], v6 offset:37376
    s_waitcnt lgkmcnt(10)
    v_mfma_f32_16x16x32_bf16 v[92:95], v[16:19], v[44:47], v[92:95]
    ds_read_b128 v[24:27], v9 offset:34816
    ds_read_b128 v[28:31], v9 offset:36864
    v_mfma_f32_16x16x32_bf16 v[96:99], v[20:23], v[44:47], v[96:99]
    ds_read_b64_tr_b16 v[32:33], v6 offset:44032
    ds_read_b64_tr_b16 v[34:35], v6 offset:46336
    s_waitcnt lgkmcnt(12)
    v_mfma_f32_16x16x32_bf16 v[100:103], v[16:19], v[48:51], v[100:103]
    ds_read_b64_tr_b16 v[36:37], v6 offset:44064
    v_mfma_f32_16x16x32_bf16 v[104:107], v[20:23], v[48:51], v[104:107]
    ds_read_b64_tr_b16 v[38:39], v6 offset:46368
    s_waitcnt lgkmcnt(12)
    v_mfma_f32_16x16x32_bf16 v[108:111], v[16:19], v[52:55], v[108:111]
    ds_read_b64_tr_b16 v[40:41], v6 offset:44096
    v_mfma_f32_16x16x32_bf16 v[112:115], v[20:23], v[52:55], v[112:115]
    ds_read_b64_tr_b16 v[42:43], v6 offset:46400
    s_waitcnt lgkmcnt(12)
    v_mfma_f32_16x16x32_bf16 v[116:119], v[16:19], v[56:59], v[116:119]
    ds_read_b64_tr_b16 v[44:45], v6 offset:44128
    v_mfma_f32_16x16x32_bf16 v[120:123], v[20:23], v[56:59], v[120:123]
    ds_read_b64_tr_b16 v[46:47], v6 offset:46432
    s_waitcnt lgkmcnt(12)
    v_mfma_f32_16x16x32_bf16 v[124:127], v[16:19], v[60:63], v[124:127]
    ds_read_b64_tr_b16 v[48:49], v6 offset:44160
    v_mfma_f32_16x16x32_bf16 v[128:131], v[20:23], v[60:63], v[128:131]
    ds_read_b64_tr_b16 v[50:51], v6 offset:46464
    s_waitcnt lgkmcnt(12)
    v_mfma_f32_16x16x32_bf16 v[132:135], v[16:19], v[64:67], v[132:135]
    ds_read_b64_tr_b16 v[52:53], v6 offset:44192
    v_mfma_f32_16x16x32_bf16 v[136:139], v[20:23], v[64:67], v[136:139]
    ds_read_b64_tr_b16 v[54:55], v6 offset:46496
    s_waitcnt lgkmcnt(10)
    v_mfma_f32_16x16x32_bf16 v[68:71], v[24:27], v[32:35], v[68:71]
    ds_read_b64_tr_b16 v[56:57], v6 offset:44224
    v_mfma_f32_16x16x32_bf16 v[72:75], v[28:31], v[32:35], v[72:75]
    ds_read_b64_tr_b16 v[58:59], v6 offset:46528
    s_waitcnt lgkmcnt(10)
    v_mfma_f32_16x16x32_bf16 v[76:79], v[24:27], v[36:39], v[76:79]
    ds_read_b64_tr_b16 v[60:61], v6 offset:44256
    v_mfma_f32_16x16x32_bf16 v[80:83], v[28:31], v[36:39], v[80:83]
    ds_read_b64_tr_b16 v[62:63], v6 offset:46560
    s_waitcnt lgkmcnt(10)
    v_mfma_f32_16x16x32_bf16 v[84:87], v[24:27], v[40:43], v[84:87]
    ds_read_b64_tr_b16 v[64:65], v6 offset:44288
    v_mfma_f32_16x16x32_bf16 v[88:91], v[28:31], v[40:43], v[88:91]
    ds_read_b64_tr_b16 v[66:67], v6 offset:46592
    s_barrier
    s_waitcnt lgkmcnt(10)
    v_mfma_f32_16x16x32_bf16 v[92:95], v[24:27], v[44:47], v[92:95]
    ds_read_b128 v[16:19], v4 offset:0
    ds_read_b128 v[20:23], v4 offset:2048
    v_mfma_f32_16x16x32_bf16 v[96:99], v[28:31], v[44:47], v[96:99]
    ds_read_b64_tr_b16 v[32:33], v2 offset:0
    ds_read_b64_tr_b16 v[34:35], v2 offset:2304
    s_waitcnt lgkmcnt(12)
    v_mfma_f32_16x16x32_bf16 v[100:103], v[24:27], v[48:51], v[100:103]
    ds_read_b128 v[140:143], v5 offset:0
    ds_read_b128 v[144:147], v5 offset:2048
    v_mfma_f32_16x16x32_bf16 v[104:107], v[28:31], v[48:51], v[104:107]
    ds_read_b64_tr_b16 v[36:37], v2 offset:9216
    s_waitcnt lgkmcnt(13)
    ds_read_b64_tr_b16 v[38:39], v2 offset:11520
    v_mfma_f32_16x16x32_bf16 v[108:111], v[24:27], v[52:55], v[108:111]
    ds_read_b64_tr_b16 v[40:41], v2 offset:32
    v_mfma_f32_16x16x32_bf16 v[112:115], v[28:31], v[52:55], v[112:115]
    s_waitcnt lgkmcnt(13)
    ds_read_b64_tr_b16 v[42:43], v2 offset:2336
    v_mfma_f32_16x16x32_bf16 v[116:119], v[24:27], v[56:59], v[116:119]
    ds_read_b64_tr_b16 v[44:45], v2 offset:9248
    v_mfma_f32_16x16x32_bf16 v[120:123], v[28:31], v[56:59], v[120:123]
    s_waitcnt lgkmcnt(13)
    ds_read_b64_tr_b16 v[46:47], v2 offset:11552
    v_mfma_f32_16x16x32_bf16 v[124:127], v[24:27], v[60:63], v[124:127]
    ds_read_b64_tr_b16 v[48:49], v2 offset:64
    v_mfma_f32_16x16x32_bf16 v[128:131], v[28:31], v[60:63], v[128:131]
    s_waitcnt lgkmcnt(13)
    ds_read_b64_tr_b16 v[50:51], v2 offset:2368
    v_mfma_f32_16x16x32_bf16 v[132:135], v[24:27], v[64:67], v[132:135]
    ds_read_b64_tr_b16 v[52:53], v2 offset:9280
    v_mfma_f32_16x16x32_bf16 v[136:139], v[28:31], v[64:67], v[136:139]
    s_waitcnt lgkmcnt(11)
    ds_read_b64_tr_b16 v[54:55], v2 offset:11584
    v_mfma_f32_16x16x32_bf16 v[68:71], v[16:19], v[32:35], v[68:71]
    ds_read_b64_tr_b16 v[56:57], v2 offset:96
    v_mfma_f32_16x16x32_bf16 v[72:75], v[20:23], v[32:35], v[72:75]
    ds_read_b64_tr_b16 v[58:59], v2 offset:2400
    s_waitcnt lgkmcnt(10)
    v_mfma_f32_16x16x32_bf16 v[68:71], v[140:143], v[36:39], v[68:71]
    ds_read_b64_tr_b16 v[60:61], v2 offset:9312
    v_mfma_f32_16x16x32_bf16 v[72:75], v[144:147], v[36:39], v[72:75]
    ds_read_b64_tr_b16 v[62:63], v2 offset:11616
    s_waitcnt lgkmcnt(10)
    v_mfma_f32_16x16x32_bf16 v[76:79], v[16:19], v[40:43], v[76:79]
    ds_read_b64_tr_b16 v[64:65], v2 offset:128
    v_mfma_f32_16x16x32_bf16 v[80:83], v[20:23], v[40:43], v[80:83]
    ds_read_b64_tr_b16 v[66:67], v2 offset:2432
    s_waitcnt lgkmcnt(10)
    v_mfma_f32_16x16x32_bf16 v[76:79], v[140:143], v[44:47], v[76:79]
    ds_read_b64_tr_b16 v[32:33], v2 offset:9344
    v_cvt_pk_bf16_f32 v148, v68, v69
    v_cvt_pk_bf16_f32 v149, v70, v71
    v_mfma_f32_16x16x32_bf16 v[80:83], v[144:147], v[44:47], v[80:83]
    ds_read_b64_tr_b16 v[34:35], v2 offset:11648
    v_cvt_pk_bf16_f32 v150, v72, v73
    v_cvt_pk_bf16_f32 v151, v74, v75
    s_waitcnt lgkmcnt(10)
    v_mfma_f32_16x16x32_bf16 v[84:87], v[16:19], v[48:51], v[84:87]
    ds_read_b64_tr_b16 v[36:37], v2 offset:160
    buffer_store_dwordx4 v[148:151], v10, s[40:43], s13 offen offset:0 sc1
    v_mfma_f32_16x16x32_bf16 v[88:91], v[20:23], v[48:51], v[88:91]
    ds_read_b64_tr_b16 v[38:39], v2 offset:2464
    s_waitcnt lgkmcnt(10)
    v_mfma_f32_16x16x32_bf16 v[84:87], v[140:143], v[52:55], v[84:87]
    ds_read_b64_tr_b16 v[40:41], v2 offset:9376
    v_cvt_pk_bf16_f32 v152, v76, v77
    v_cvt_pk_bf16_f32 v153, v78, v79
    v_mfma_f32_16x16x32_bf16 v[88:91], v[144:147], v[52:55], v[88:91]
    ds_read_b64_tr_b16 v[42:43], v2 offset:11680
    v_cvt_pk_bf16_f32 v154, v80, v81
    v_cvt_pk_bf16_f32 v155, v82, v83
    s_waitcnt lgkmcnt(10)
    v_mfma_f32_16x16x32_bf16 v[92:95], v[16:19], v[56:59], v[92:95]
    ds_read_b64_tr_b16 v[44:45], v2 offset:192
    buffer_store_dwordx4 v[152:155], v10, s[40:43], s13 offen offset:256 sc1
    v_mfma_f32_16x16x32_bf16 v[96:99], v[20:23], v[56:59], v[96:99]
    ds_read_b64_tr_b16 v[46:47], v2 offset:2496
    s_waitcnt lgkmcnt(10)
    v_mfma_f32_16x16x32_bf16 v[92:95], v[140:143], v[60:63], v[92:95]
    ds_read_b64_tr_b16 v[48:49], v2 offset:9408
    v_cvt_pk_bf16_f32 v156, v84, v85
    v_cvt_pk_bf16_f32 v157, v86, v87
    v_mfma_f32_16x16x32_bf16 v[96:99], v[144:147], v[60:63], v[96:99]
    ds_read_b64_tr_b16 v[50:51], v2 offset:11712
    v_cvt_pk_bf16_f32 v158, v88, v89
    v_cvt_pk_bf16_f32 v159, v90, v91
    s_waitcnt lgkmcnt(10)
    v_mfma_f32_16x16x32_bf16 v[100:103], v[16:19], v[64:67], v[100:103]
    ds_read_b64_tr_b16 v[52:53], v2 offset:224
    buffer_store_dwordx4 v[156:159], v10, s[40:43], s13 offen offset:512 sc1
    v_mfma_f32_16x16x32_bf16 v[104:107], v[20:23], v[64:67], v[104:107]
    ds_read_b64_tr_b16 v[54:55], v2 offset:2528
    s_waitcnt lgkmcnt(10)
    v_mfma_f32_16x16x32_bf16 v[100:103], v[140:143], v[32:35], v[100:103]
    ds_read_b64_tr_b16 v[56:57], v2 offset:9440
    v_cvt_pk_bf16_f32 v160, v92, v93
    v_cvt_pk_bf16_f32 v161, v94, v95
    v_mfma_f32_16x16x32_bf16 v[104:107], v[144:147], v[32:35], v[104:107]
    ds_read_b64_tr_b16 v[58:59], v2 offset:11744
    v_cvt_pk_bf16_f32 v162, v96, v97
    v_cvt_pk_bf16_f32 v163, v98, v99
    s_waitcnt lgkmcnt(10)
    v_mfma_f32_16x16x32_bf16 v[108:111], v[16:19], v[36:39], v[108:111]
    ds_read_b64_tr_b16 v[60:61], v2 offset:256
    buffer_store_dwordx4 v[160:163], v10, s[40:43], s13 offen offset:768 sc1
    v_mfma_f32_16x16x32_bf16 v[112:115], v[20:23], v[36:39], v[112:115]
    ds_read_b64_tr_b16 v[62:63], v2 offset:2560
    s_waitcnt lgkmcnt(10)
    v_mfma_f32_16x16x32_bf16 v[108:111], v[140:143], v[40:43], v[108:111]
    ds_read_b64_tr_b16 v[64:65], v2 offset:9472
    v_cvt_pk_bf16_f32 v164, v100, v101
    v_cvt_pk_bf16_f32 v165, v102, v103
    v_mfma_f32_16x16x32_bf16 v[112:115], v[144:147], v[40:43], v[112:115]
    ds_read_b64_tr_b16 v[66:67], v2 offset:11776
    v_cvt_pk_bf16_f32 v166, v104, v105
    v_cvt_pk_bf16_f32 v167, v106, v107
    s_waitcnt lgkmcnt(10)
    v_mfma_f32_16x16x32_bf16 v[116:119], v[16:19], v[44:47], v[116:119]
    buffer_store_dwordx4 v[164:167], v10, s[40:43], s13 offen offset:1024 sc1
    v_mfma_f32_16x16x32_bf16 v[120:123], v[20:23], v[44:47], v[120:123]
    s_waitcnt lgkmcnt(8)
    v_mfma_f32_16x16x32_bf16 v[116:119], v[140:143], v[48:51], v[116:119]
    v_cvt_pk_bf16_f32 v168, v108, v109
    v_cvt_pk_bf16_f32 v169, v110, v111
    v_mfma_f32_16x16x32_bf16 v[120:123], v[144:147], v[48:51], v[120:123]
    v_cvt_pk_bf16_f32 v170, v112, v113
    v_cvt_pk_bf16_f32 v171, v114, v115
    s_waitcnt lgkmcnt(6)
    v_mfma_f32_16x16x32_bf16 v[124:127], v[16:19], v[52:55], v[124:127]
    buffer_store_dwordx4 v[168:171], v10, s[40:43], s13 offen offset:1280 sc1
    v_mfma_f32_16x16x32_bf16 v[128:131], v[20:23], v[52:55], v[128:131]
    s_waitcnt lgkmcnt(4)
    v_mfma_f32_16x16x32_bf16 v[124:127], v[140:143], v[56:59], v[124:127]
    v_cvt_pk_bf16_f32 v172, v116, v117
    v_cvt_pk_bf16_f32 v173, v118, v119
    v_mfma_f32_16x16x32_bf16 v[128:131], v[144:147], v[56:59], v[128:131]
    v_cvt_pk_bf16_f32 v174, v120, v121
    v_cvt_pk_bf16_f32 v175, v122, v123
    s_waitcnt lgkmcnt(2)
    v_mfma_f32_16x16x32_bf16 v[132:135], v[16:19], v[60:63], v[132:135]
    buffer_store_dwordx4 v[172:175], v10, s[40:43], s13 offen offset:1536 sc1
    v_mfma_f32_16x16x32_bf16 v[136:139], v[20:23], v[60:63], v[136:139]
    s_waitcnt lgkmcnt(0)
    v_mfma_f32_16x16x32_bf16 v[132:135], v[140:143], v[64:67], v[132:135]
    v_cvt_pk_bf16_f32 v176, v124, v125
    v_cvt_pk_bf16_f32 v177, v126, v127
    v_mfma_f32_16x16x32_bf16 v[136:139], v[144:147], v[64:67], v[136:139]
    v_cvt_pk_bf16_f32 v178, v128, v129
    v_cvt_pk_bf16_f32 v179, v130, v131
    buffer_store_dwordx4 v[176:179], v10, s[40:43], s13 offen offset:1792 sc1
    s_nop 1
    v_cvt_pk_bf16_f32 v180, v132, v133
    v_cvt_pk_bf16_f32 v181, v134, v135
    s_nop 0
    v_cvt_pk_bf16_f32 v182, v136, v137
    v_cvt_pk_bf16_f32 v183, v138, v139
    buffer_store_dwordx4 v[180:183], v10, s[40:43], s13 offen offset:2048 sc1
    s_branch GC_POST
GC_POST:
    s_mov_b32 s101, 0
    s_mov_b32 s29, 0
    s_mov_b32 s10, 0
    s_waitcnt vmcnt(9)
    v_readfirstlane_b32 s56, v236
    v_readfirstlane_b32 s57, v237
    s_nop 0
    s_cmp_lg_u64 s[56:57], 0
    s_cbranch_scc1 TF5
    s_mov_b32 s52, s36
    s_mov_b32 s53, s37
    s_mov_b32 s54, 256
    s_mov_b32 s55, 0x00020000
    v_mov_b32 v238, 0
    s_mov_b32 s58, 0
GT6:
    buffer_load_dwordx2 v[236:237], v238, s[52:55], 0 offen sc1
    s_add_u32 s58, s58, 1
    s_waitcnt vmcnt(0)
    v_readfirstlane_b32 s56, v236
    v_readfirstlane_b32 s57, v237
    s_nop 0
    s_cmp_lg_u64 s[56:57], 0
    s_cbranch_scc1 GD7
    s_cmp_lt_u32 s58, 200000
    s_cbranch_scc1 GT6
GD7:
TF5:
    s_lshl_b32 s9, s3, 2
    s_add_u32 s9, s9, 39008
    v_mov_b32 v2, s9
    v_mov_b32 v3, s56
    ds_write_b32 v2, v3
    s_branch M_AL
M_S1:
    s_sub_u32 s4, s2, 192
    s_lshl_b32 s5, s15, 6
    s_add_u32 s5, s5, s4
    s_and_b32 s6, s4, 7
    s_lshr_b32 s7, s5, 3
    s_cmp_ge_u32 s5, 256
    s_cselect_b32 s6, 8, s6
    s_cselect_b32 s7, s4, s7
    s_cmp_ge_u32 s5, 288
    s_cbranch_scc1 G1_SKIP
    v_and_b32 v10, 7, v1
    v_lshrrev_b32 v11, 3, v1
    s_lshl_b32 s9, s7, 3
    v_add_u32 v3, s9, v11
    s_lshl_b32 s8, s6, 3
    v_add_u32 v2, s8, v10
    v_mul_u32_u24 v5, 9216, v3
    v_lshl_add_u32 v5, v2, 4, v5
    v_subrev_u32 v4, 4608, v5
    v_add_u32 v6, 4608, v5
    v_xor_b32 v12, v10, v11
    v_lshl_add_u32 v13, v10, 3, v12
    s_lshr_b32 s10, s15, 1
    s_mul_i32 s10, s10, 17600
    s_lshl_b32 s11, s15, 12
    s_add_u32 s10, s10, s11
    s_add_u32 s10, s10, 26624
    v_lshl_add_u32 v13, v13, 4, s10
    v_lshl_add_u32 v14, v1, 4, s10
    v_add_u32 v8, s8, v11
    v_lshlrev_b32 v8, 15, v8
    v_add_u32 v9, s9, v12
    v_lshlrev_b32 v9, 4, v9
    v_sub_u32 v8, v8, v9
    v_add_u32 v8, 10489840, v8
    s_waitcnt lgkmcnt(0)
    s_mov_b32 s40, s38
    s_mov_b32 s41, s39
    s_mov_b32 s42, 17432576
    s_mov_b32 s43, 0x00020000
    s_mov_b32 s44, s24
    s_mov_b32 s45, s25
    s_mov_b32 s46, 2359296
    s_mov_b32 s47, 0x00020000
    s_mov_b32 s48, s26
    s_mov_b32 s49, s27
    s_mov_b32 s50, 2359296
    s_mov_b32 s51, 0x00020000
    s_mov_b32 s52, s28
    s_mov_b32 s53, s29
    s_mov_b32 s54, 4608
    s_mov_b32 s55, 0x00020000
    s_add_u32 m0, s10, 3072
    s_lshl_b32 s11, s6, 9
    v_lshlrev_b32 v7, 4, v1
    s_mov_b32 exec_hi, 0
    buffer_load_dwordx4 v7, s[52:55], s11 offen lds
    s_mov_b32 exec_hi, -1
    buffer_load_dwordx4 v[48:51], v6, s[44:47], 0 offen offset:1152 nt
    buffer_load_dwordx4 v[52:55], v6, s[44:47], 0 offen offset:2304 nt
    buffer_load_dwordx4 v[56:59], v6, s[44:47], 0 offen offset:3456 nt
    s_mov_b64 exec, 0xff
    buffer_load_dwordx4 v[16:19], v4, s[44:47], 0 offen offset:1152 nt
    buffer_load_dwordx4 v[20:23], v4, s[44:47], 0 offen offset:2304 nt
    buffer_load_dwordx4 v[24:27], v4, s[44:47], 0 offen offset:3456 nt
    s_mov_b64 exec, -1
    buffer_load_dwordx4 v[28:31], v5, s[44:47], 0 offen offset:0 nt
    buffer_load_dwordx4 v[32:35], v5, s[44:47], 0 offen offset:1152 nt
    buffer_load_dwordx4 v[36:39], v5, s[44:47], 0 offen offset:2304 nt
    buffer_load_dwordx4 v[40:43], v5, s[44:47], 0 offen offset:3456 nt
    buffer_load_dwordx4 v[44:47], v6, s[44:47], 0 offen offset:0 nt
    s_barrier
    buffer_load_dwordx4 v[60:63], v5, s[48:51], 0 offen offset:0 nt
    buffer_load_dwordx4 v[64:67], v5, s[48:51], 0 offen offset:1152 nt
    buffer_load_dwordx4 v[68:71], v5, s[48:51], 0 offen offset:2304 nt
    buffer_load_dwordx4 v[72:75], v5, s[48:51], 0 offen offset:3456 nt
    buffer_load_dwordx4 v[76:79], v6, s[48:51], 0 offen offset:0 nt
    buffer_load_dwordx4 v[80:83], v6, s[48:51], 0 offen offset:1152 nt
    buffer_load_dwordx4 v[84:87], v6, s[48:51], 0 offen offset:2304 nt
    buffer_load_dwordx4 v[88:91], v6, s[48:51], 0 offen offset:3456 nt
    s_getpc_b64 s[58:59]
    v_lshlrev_b32 v15, 7, v1
    s_mov_b32 exec_hi, 0
    global_load_dword v252, v15, s[58:59]
    s_mov_b32 exec_hi, -1
    s_mov_b32 s9, 0xffff0000
    v_lshl_add_u32 v7, v10, 6, s10
    v_subrev_u32 v9, 128, v14
    s_waitcnt vmcnt(14)
    ds_read_b128 v[92:95], v7 offset:3072
    ds_read_b128 v[96:99], v7 offset:3088
    ds_read_b128 v[100:103], v7 offset:3104
    ds_read_b128 v[104:107], v7 offset:3120
    ds_write_b128 v14, v[48:51] offset:0
    ds_write_b128 v14, v[52:55] offset:1024
    ds_write_b128 v14, v[56:59] offset:2048
    s_mov_b32 exec_lo, 0xffffff00
    ds_read_b128 v[16:19], v9 offset:0
    ds_read_b128 v[20:23], v9 offset:1024
    ds_read_b128 v[24:27], v9 offset:2048
    s_mov_b32 exec_lo, -1
    s_waitcnt lgkmcnt(0)
    v_lshlrev_b32 v108, 16, v92
    v_and_b32 v110, s9, v92
    v_lshlrev_b32 v112, 16, v93
    v_and_b32 v114, s9, v93
    v_lshlrev_b32 v109, 16, v94
    v_and_b32 v111, s9, v94
    v_lshlrev_b32 v113, 16, v95
    v_and_b32 v115, s9, v95
    v_lshlrev_b32 v116, 16, v96
    v_and_b32 v118, s9, v96
    v_lshlrev_b32 v120, 16, v97
    v_and_b32 v122, s9, v97
    v_lshlrev_b32 v117, 16, v98
    v_and_b32 v119, s9, v98
    v_lshlrev_b32 v121, 16, v99
    v_and_b32 v123, s9, v99
    v_lshlrev_b32 v124, 16, v100
    v_and_b32 v126, s9, v100
    v_lshlrev_b32 v128, 16, v101
    v_and_b32 v130, s9, v101
    v_lshlrev_b32 v125, 16, v102
    v_and_b32 v127, s9, v102
    v_lshlrev_b32 v129, 16, v103
    v_and_b32 v131, s9, v103
    v_lshlrev_b32 v132, 16, v104
    v_and_b32 v134, s9, v104
    v_lshlrev_b32 v136, 16, v105
    v_and_b32 v138, s9, v105
    v_lshlrev_b32 v133, 16, v106
    v_and_b32 v135, s9, v106
    v_lshlrev_b32 v137, 16, v107
    v_and_b32 v139, s9, v107
    s_waitcnt vmcnt(9)
    v_lshlrev_b32 v140, 16, v16
    v_and_b32 v141, s9, v16
    v_lshlrev_b32 v142, 16, v20
    v_and_b32 v143, s9, v20
    v_lshlrev_b32 v144, 16, v24
    v_and_b32 v145, s9, v24
    v_lshlrev_b32 v146, 16, v28
    v_and_b32 v147, s9, v28
    v_lshlrev_b32 v148, 16, v32
    v_and_b32 v149, s9, v32
    v_lshlrev_b32 v150, 16, v36
    v_and_b32 v151, s9, v36
    v_lshlrev_b32 v152, 16, v40
    v_and_b32 v153, s9, v40
    v_lshlrev_b32 v154, 16, v44
    v_and_b32 v155, s9, v44
    v_lshlrev_b32 v156, 16, v48
    v_and_b32 v157, s9, v48
    v_lshlrev_b32 v158, 16, v52
    v_and_b32 v159, s9, v52
    v_lshlrev_b32 v160, 16, v56
    v_and_b32 v161, s9, v56
    v_pk_mul_f32 v[162:163], v[140:141], v[114:115]
    v_pk_mul_f32 v[164:165], v[142:143], v[114:115]
    v_pk_mul_f32 v[166:167], v[144:145], v[114:115]
    v_pk_mul_f32 v[168:169], v[146:147], v[114:115]
    v_pk_mul_f32 v[170:171], v[148:149], v[114:115]
    v_pk_mul_f32 v[172:173], v[150:151], v[114:115]
    v_pk_mul_f32 v[174:175], v[152:153], v[114:115]
    v_pk_mul_f32 v[176:177], v[154:155], v[114:115]
    v_pk_fma_f32 v[162:163], v[142:143], v[112:113], v[162:163]
    v_pk_fma_f32 v[164:165], v[144:145], v[112:113], v[164:165]
    v_pk_fma_f32 v[166:167], v[146:147], v[112:113], v[166:167]
    v_pk_fma_f32 v[168:169], v[148:149], v[112:113], v[168:169]
    v_pk_fma_f32 v[170:171], v[150:151], v[112:113], v[170:171]
    v_pk_fma_f32 v[172:173], v[152:153], v[112:113], v[172:173]
    v_pk_fma_f32 v[174:175], v[154:155], v[112:113], v[174:175]
    v_pk_fma_f32 v[176:177], v[156:157], v[112:113], v[176:177]
    v_pk_fma_f32 v[162:163], v[144:145], v[110:111], v[162:163]
    v_pk_fma_f32 v[164:165], v[146:147], v[110:111], v[164:165]
    v_pk_fma_f32 v[166:167], v[148:149], v[110:111], v[166:167]
    v_pk_fma_f32 v[168:169], v[150:151], v[110:111], v[168:169]
    v_pk_fma_f32 v[170:171], v[152:153], v[110:111], v[170:171]
    v_pk_fma_f32 v[172:173], v[154:155], v[110:111], v[172:173]
    v_pk_fma_f32 v[174:175], v[156:157], v[110:111], v[174:175]
    v_pk_fma_f32 v[176:177], v[158:159], v[110:111], v[176:177]
    v_pk_fma_f32 v[162:163], v[146:147], v[108:109], v[162:163]
    v_pk_fma_f32 v[164:165], v[148:149], v[108:109], v[164:165]
    v_pk_fma_f32 v[166:167], v[150:151], v[108:109], v[166:167]
    v_pk_fma_f32 v[168:169], v[152:153], v[108:109], v[168:169]
    v_pk_fma_f32 v[170:171], v[154:155], v[108:109], v[170:171]
    v_pk_fma_f32 v[172:173], v[156:157], v[108:109], v[172:173]
    v_pk_fma_f32 v[174:175], v[158:159], v[108:109], v[174:175]
    v_pk_fma_f32 v[176:177], v[160:161], v[108:109], v[176:177]
    v_lshlrev_b32 v140, 16, v17
    v_and_b32 v141, s9, v17
    v_lshlrev_b32 v142, 16, v21
    v_and_b32 v143, s9, v21
    v_lshlrev_b32 v144, 16, v25
    v_and_b32 v145, s9, v25
    v_lshlrev_b32 v146, 16, v29
    v_and_b32 v147, s9, v29
    v_lshlrev_b32 v148, 16, v33
    v_and_b32 v149, s9, v33
    v_lshlrev_b32 v150, 16, v37
    v_and_b32 v151, s9, v37
    v_lshlrev_b32 v152, 16, v41
    v_and_b32 v153, s9, v41
    v_lshlrev_b32 v154, 16, v45
    v_and_b32 v155, s9, v45
    v_lshlrev_b32 v156, 16, v49
    v_and_b32 v157, s9, v49
    v_lshlrev_b32 v158, 16, v53
    v_and_b32 v159, s9, v53
    v_lshlrev_b32 v160, 16, v57
    v_and_b32 v161, s9, v57
    v_pk_mul_f32 v[178:179], v[140:141], v[122:123]
    v_pk_mul_f32 v[180:181], v[142:143], v[122:123]
    v_pk_mul_f32 v[182:183], v[144:145], v[122:123]
    v_pk_mul_f32 v[184:185], v[146:147], v[122:123]
    v_pk_mul_f32 v[186:187], v[148:149], v[122:123]
    v_pk_mul_f32 v[188:189], v[150:151], v[122:123]
    v_pk_mul_f32 v[190:191], v[152:153], v[122:123]
    v_pk_mul_f32 v[192:193], v[154:155], v[122:123]
    v_pk_fma_f32 v[178:179], v[142:143], v[120:121], v[178:179]
    v_pk_fma_f32 v[180:181], v[144:145], v[120:121], v[180:181]
    v_pk_fma_f32 v[182:183], v[146:147], v[120:121], v[182:183]
    v_pk_fma_f32 v[184:185], v[148:149], v[120:121], v[184:185]
    v_pk_fma_f32 v[186:187], v[150:151], v[120:121], v[186:187]
    v_pk_fma_f32 v[188:189], v[152:153], v[120:121], v[188:189]
    v_pk_fma_f32 v[190:191], v[154:155], v[120:121], v[190:191]
    v_pk_fma_f32 v[192:193], v[156:157], v[120:121], v[192:193]
    v_pk_fma_f32 v[178:179], v[144:145], v[118:119], v[178:179]
    v_pk_fma_f32 v[180:181], v[146:147], v[118:119], v[180:181]
    v_pk_fma_f32 v[182:183], v[148:149], v[118:119], v[182:183]
    v_pk_fma_f32 v[184:185], v[150:151], v[118:119], v[184:185]
    v_pk_fma_f32 v[186:187], v[152:153], v[118:119], v[186:187]
    v_pk_fma_f32 v[188:189], v[154:155], v[118:119], v[188:189]
    v_pk_fma_f32 v[190:191], v[156:157], v[118:119], v[190:191]
    v_pk_fma_f32 v[192:193], v[158:159], v[118:119], v[192:193]
    v_pk_fma_f32 v[178:179], v[146:147], v[116:117], v[178:179]
    v_pk_fma_f32 v[180:181], v[148:149], v[116:117], v[180:181]
    v_pk_fma_f32 v[182:183], v[150:151], v[116:117], v[182:183]
    v_pk_fma_f32 v[184:185], v[152:153], v[116:117], v[184:185]
    v_pk_fma_f32 v[186:187], v[154:155], v[116:117], v[186:187]
    v_pk_fma_f32 v[188:189], v[156:157], v[116:117], v[188:189]
    v_pk_fma_f32 v[190:191], v[158:159], v[116:117], v[190:191]
    v_pk_fma_f32 v[192:193], v[160:161], v[116:117], v[192:193]
    v_lshlrev_b32 v140, 16, v18
    v_and_b32 v141, s9, v18
    v_lshlrev_b32 v142, 16, v22
    v_and_b32 v143, s9, v22
    v_lshlrev_b32 v144, 16, v26
    v_and_b32 v145, s9, v26
    v_lshlrev_b32 v146, 16, v30
    v_and_b32 v147, s9, v30
    v_lshlrev_b32 v148, 16, v34
    v_and_b32 v149, s9, v34
    v_lshlrev_b32 v150, 16, v38
    v_and_b32 v151, s9, v38
    v_lshlrev_b32 v152, 16, v42
    v_and_b32 v153, s9, v42
    v_lshlrev_b32 v154, 16, v46
    v_and_b32 v155, s9, v46
    v_lshlrev_b32 v156, 16, v50
    v_and_b32 v157, s9, v50
    v_lshlrev_b32 v158, 16, v54
    v_and_b32 v159, s9, v54
    v_lshlrev_b32 v160, 16, v58
    v_and_b32 v161, s9, v58
    v_pk_mul_f32 v[194:195], v[140:141], v[130:131]
    v_pk_mul_f32 v[196:197], v[142:143], v[130:131]
    v_pk_mul_f32 v[198:199], v[144:145], v[130:131]
    v_pk_mul_f32 v[200:201], v[146:147], v[130:131]
    v_pk_mul_f32 v[202:203], v[148:149], v[130:131]
    v_pk_mul_f32 v[204:205], v[150:151], v[130:131]
    v_pk_mul_f32 v[206:207], v[152:153], v[130:131]
    v_pk_mul_f32 v[208:209], v[154:155], v[130:131]
    v_pk_fma_f32 v[194:195], v[142:143], v[128:129], v[194:195]
    v_pk_fma_f32 v[196:197], v[144:145], v[128:129], v[196:197]
    v_pk_fma_f32 v[198:199], v[146:147], v[128:129], v[198:199]
    v_pk_fma_f32 v[200:201], v[148:149], v[128:129], v[200:201]
    v_pk_fma_f32 v[202:203], v[150:151], v[128:129], v[202:203]
    v_pk_fma_f32 v[204:205], v[152:153], v[128:129], v[204:205]
    v_pk_fma_f32 v[206:207], v[154:155], v[128:129], v[206:207]
    v_pk_fma_f32 v[208:209], v[156:157], v[128:129], v[208:209]
    v_pk_fma_f32 v[194:195], v[144:145], v[126:127], v[194:195]
    v_pk_fma_f32 v[196:197], v[146:147], v[126:127], v[196:197]
    v_pk_fma_f32 v[198:199], v[148:149], v[126:127], v[198:199]
    v_pk_fma_f32 v[200:201], v[150:151], v[126:127], v[200:201]
    v_pk_fma_f32 v[202:203], v[152:153], v[126:127], v[202:203]
    v_pk_fma_f32 v[204:205], v[154:155], v[126:127], v[204:205]
    v_pk_fma_f32 v[206:207], v[156:157], v[126:127], v[206:207]
    v_pk_fma_f32 v[208:209], v[158:159], v[126:127], v[208:209]
    v_pk_fma_f32 v[194:195], v[146:147], v[124:125], v[194:195]
    v_pk_fma_f32 v[196:197], v[148:149], v[124:125], v[196:197]
    v_pk_fma_f32 v[198:199], v[150:151], v[124:125], v[198:199]
    v_pk_fma_f32 v[200:201], v[152:153], v[124:125], v[200:201]
    v_pk_fma_f32 v[202:203], v[154:155], v[124:125], v[202:203]
    v_pk_fma_f32 v[204:205], v[156:157], v[124:125], v[204:205]
    v_pk_fma_f32 v[206:207], v[158:159], v[124:125], v[206:207]
    v_pk_fma_f32 v[208:209], v[160:161], v[124:125], v[208:209]
    v_lshlrev_b32 v140, 16, v19
    v_and_b32 v141, s9, v19
    v_lshlrev_b32 v142, 16, v23
    v_and_b32 v143, s9, v23
    v_lshlrev_b32 v144, 16, v27
    v_and_b32 v145, s9, v27
    v_lshlrev_b32 v146, 16, v31
    v_and_b32 v147, s9, v31
    v_lshlrev_b32 v148, 16, v35
    v_and_b32 v149, s9, v35
    v_lshlrev_b32 v150, 16, v39
    v_and_b32 v151, s9, v39
    v_lshlrev_b32 v152, 16, v43
    v_and_b32 v153, s9, v43
    v_lshlrev_b32 v154, 16, v47
    v_and_b32 v155, s9, v47
    v_lshlrev_b32 v156, 16, v51
    v_and_b32 v157, s9, v51
    v_lshlrev_b32 v158, 16, v55
    v_and_b32 v159, s9, v55
    v_lshlrev_b32 v160, 16, v59
    v_and_b32 v161, s9, v59
    v_pk_mul_f32 v[210:211], v[140:141], v[138:139]
    v_pk_mul_f32 v[212:213], v[142:143], v[138:139]
    v_pk_mul_f32 v[214:215], v[144:145], v[138:139]
    v_pk_mul_f32 v[216:217], v[146:147], v[138:139]
    v_pk_mul_f32 v[218:219], v[148:149], v[138:139]
    v_pk_mul_f32 v[220:221], v[150:151], v[138:139]
    v_pk_mul_f32 v[222:223], v[152:153], v[138:139]
    v_pk_mul_f32 v[224:225], v[154:155], v[138:139]
    v_pk_fma_f32 v[210:211], v[142:143], v[136:137], v[210:211]
    v_pk_fma_f32 v[212:213], v[144:145], v[136:137], v[212:213]
    v_pk_fma_f32 v[214:215], v[146:147], v[136:137], v[214:215]
    v_pk_fma_f32 v[216:217], v[148:149], v[136:137], v[216:217]
    v_pk_fma_f32 v[218:219], v[150:151], v[136:137], v[218:219]
    v_pk_fma_f32 v[220:221], v[152:153], v[136:137], v[220:221]
    v_pk_fma_f32 v[222:223], v[154:155], v[136:137], v[222:223]
    v_pk_fma_f32 v[224:225], v[156:157], v[136:137], v[224:225]
    v_pk_fma_f32 v[210:211], v[144:145], v[134:135], v[210:211]
    v_pk_fma_f32 v[212:213], v[146:147], v[134:135], v[212:213]
    v_pk_fma_f32 v[214:215], v[148:149], v[134:135], v[214:215]
    v_pk_fma_f32 v[216:217], v[150:151], v[134:135], v[216:217]
    v_pk_fma_f32 v[218:219], v[152:153], v[134:135], v[218:219]
    v_pk_fma_f32 v[220:221], v[154:155], v[134:135], v[220:221]
    v_pk_fma_f32 v[222:223], v[156:157], v[134:135], v[222:223]
    v_pk_fma_f32 v[224:225], v[158:159], v[134:135], v[224:225]
    v_pk_fma_f32 v[210:211], v[146:147], v[132:133], v[210:211]
    v_pk_fma_f32 v[212:213], v[148:149], v[132:133], v[212:213]
    v_pk_fma_f32 v[214:215], v[150:151], v[132:133], v[214:215]
    v_pk_fma_f32 v[216:217], v[152:153], v[132:133], v[216:217]
    v_pk_fma_f32 v[218:219], v[154:155], v[132:133], v[218:219]
    v_pk_fma_f32 v[220:221], v[156:157], v[132:133], v[220:221]
    v_pk_fma_f32 v[222:223], v[158:159], v[132:133], v[222:223]
    v_pk_fma_f32 v[224:225], v[160:161], v[132:133], v[224:225]
    s_mov_b32 s52, s36
    s_mov_b32 s53, s37
    s_mov_b32 s54, 256
    s_mov_b32 s55, 0x00020000
    v_mov_b32 v238, 0
    buffer_load_dwordx2 v[236:237], v238, s[52:55], 0 offen sc1
    s_getpc_b64 s[58:59]
LPC3:
    s_add_u32 s58, s58, M_TAB-LPC3
    s_addc_u32 s59, s59, 0
    s_load_dwordx16 s[64:79], s[58:59], 0
    s_load_dwordx16 s[80:95], s[58:59], 64
    v_lshlrev_b32 v251, 4, v1
    global_load_dwordx4 v[228:231], v251, s[58:59] offset:128
    global_load_dwordx4 v[232:235], v251, s[58:59] offset:1152
    global_load_dwordx4 v[240:243], v251, s[58:59] offset:2176
    global_load_dwordx4 v[244:247], v251, s[58:59] offset:3200
    s_waitcnt vmcnt(6)
    v_lshlrev_b32 v16, 16, v60
    v_and_b32 v17, s9, v60
    v_lshlrev_b32 v18, 16, v64
    v_and_b32 v19, s9, v64
    v_lshlrev_b32 v20, 16, v68
    v_and_b32 v21, s9, v68
    v_lshlrev_b32 v22, 16, v72
    v_and_b32 v23, s9, v72
    v_lshlrev_b32 v24, 16, v76
    v_and_b32 v25, s9, v76
    v_lshlrev_b32 v26, 16, v80
    v_and_b32 v27, s9, v80
    v_lshlrev_b32 v28, 16, v84
    v_and_b32 v29, s9, v84
    v_lshlrev_b32 v30, 16, v88
    v_and_b32 v31, s9, v88
    v_pk_mul_f32 v[162:163], v[162:163], v[16:17]
    v_pk_mul_f32 v[164:165], v[164:165], v[18:19]
    v_pk_mul_f32 v[166:167], v[166:167], v[20:21]
    v_pk_mul_f32 v[168:169], v[168:169], v[22:23]
    v_pk_mul_f32 v[170:171], v[170:171], v[24:25]
    v_pk_mul_f32 v[172:173], v[172:173], v[26:27]
    v_pk_mul_f32 v[174:175], v[174:175], v[28:29]
    v_pk_mul_f32 v[176:177], v[176:177], v[30:31]
    v_cvt_pk_bf16_f32 v32, v176, v174
    v_cvt_pk_bf16_f32 v33, v172, v170
    v_cvt_pk_bf16_f32 v34, v168, v166
    v_cvt_pk_bf16_f32 v35, v164, v162
    ds_write_b128 v13, v[32:35] offset:0
    v_cvt_pk_bf16_f32 v36, v177, v175
    v_cvt_pk_bf16_f32 v37, v173, v171
    v_cvt_pk_bf16_f32 v38, v169, v167
    v_cvt_pk_bf16_f32 v39, v165, v163
    ds_write_b128 v13, v[36:39] offset:1024
    ds_read_b128 v[40:43], v14 offset:0
    ds_read_b128 v[44:47], v14 offset:1024
    v_lshlrev_b32 v16, 16, v61
    v_and_b32 v17, s9, v61
    v_lshlrev_b32 v18, 16, v65
    v_and_b32 v19, s9, v65
    v_lshlrev_b32 v20, 16, v69
    v_and_b32 v21, s9, v69
    v_lshlrev_b32 v22, 16, v73
    v_and_b32 v23, s9, v73
    v_lshlrev_b32 v24, 16, v77
    v_and_b32 v25, s9, v77
    v_lshlrev_b32 v26, 16, v81
    v_and_b32 v27, s9, v81
    v_lshlrev_b32 v28, 16, v85
    v_and_b32 v29, s9, v85
    v_lshlrev_b32 v30, 16, v89
    v_and_b32 v31, s9, v89
    s_waitcnt lgkmcnt(0)
    s_mov_b32 s10, 0
    buffer_store_dwordx4 v[40:43], v8, s[40:43], s10 offen sc1
    s_mov_b32 s10, 4096
    buffer_store_dwordx4 v[44:47], v8, s[40:43], s10 offen sc1
    v_pk_mul_f32 v[178:179], v[178:179], v[16:17]
    v_pk_mul_f32 v[180:181], v[180:181], v[18:19]
    v_pk_mul_f32 v[182:183], v[182:183], v[20:21]
    v_pk_mul_f32 v[184:185], v[184:185], v[22:23]
    v_pk_mul_f32 v[186:187], v[186:187], v[24:25]
    v_pk_mul_f32 v[188:189], v[188:189], v[26:27]
    v_pk_mul_f32 v[190:191], v[190:191], v[28:29]
    v_pk_mul_f32 v[192:193], v[192:193], v[30:31]
    v_cvt_pk_bf16_f32 v32, v192, v190
    v_cvt_pk_bf16_f32 v33, v188, v186
    v_cvt_pk_bf16_f32 v34, v184, v182
    v_cvt_pk_bf16_f32 v35, v180, v178
    ds_write_b128 v13, v[32:35] offset:0
    v_cvt_pk_bf16_f32 v36, v193, v191
    v_cvt_pk_bf16_f32 v37, v189, v187
    v_cvt_pk_bf16_f32 v38, v185, v183
    v_cvt_pk_bf16_f32 v39, v181, v179
    ds_write_b128 v13, v[36:39] offset:1024
    ds_read_b128 v[40:43], v14 offset:0
    ds_read_b128 v[44:47], v14 offset:1024
    v_lshlrev_b32 v16, 16, v62
    v_and_b32 v17, s9, v62
    v_lshlrev_b32 v18, 16, v66
    v_and_b32 v19, s9, v66
    v_lshlrev_b32 v20, 16, v70
    v_and_b32 v21, s9, v70
    v_lshlrev_b32 v22, 16, v74
    v_and_b32 v23, s9, v74
    v_lshlrev_b32 v24, 16, v78
    v_and_b32 v25, s9, v78
    v_lshlrev_b32 v26, 16, v82
    v_and_b32 v27, s9, v82
    v_lshlrev_b32 v28, 16, v86
    v_and_b32 v29, s9, v86
    v_lshlrev_b32 v30, 16, v90
    v_and_b32 v31, s9, v90
    s_waitcnt lgkmcnt(0)
    s_mov_b32 s10, 8192
    buffer_store_dwordx4 v[40:43], v8, s[40:43], s10 offen sc1
    s_mov_b32 s10, 12288
    buffer_store_dwordx4 v[44:47], v8, s[40:43], s10 offen sc1
    v_pk_mul_f32 v[194:195], v[194:195], v[16:17]
    v_pk_mul_f32 v[196:197], v[196:197], v[18:19]
    v_pk_mul_f32 v[198:199], v[198:199], v[20:21]
    v_pk_mul_f32 v[200:201], v[200:201], v[22:23]
    v_pk_mul_f32 v[202:203], v[202:203], v[24:25]
    v_pk_mul_f32 v[204:205], v[204:205], v[26:27]
    v_pk_mul_f32 v[206:207], v[206:207], v[28:29]
    v_pk_mul_f32 v[208:209], v[208:209], v[30:31]
    v_cvt_pk_bf16_f32 v32, v208, v206
    v_cvt_pk_bf16_f32 v33, v204, v202
    v_cvt_pk_bf16_f32 v34, v200, v198
    v_cvt_pk_bf16_f32 v35, v196, v194
    ds_write_b128 v13, v[32:35] offset:0
    v_cvt_pk_bf16_f32 v36, v209, v207
    v_cvt_pk_bf16_f32 v37, v205, v203
    v_cvt_pk_bf16_f32 v38, v201, v199
    v_cvt_pk_bf16_f32 v39, v197, v195
    ds_write_b128 v13, v[36:39] offset:1024
    ds_read_b128 v[40:43], v14 offset:0
    ds_read_b128 v[44:47], v14 offset:1024
    v_lshlrev_b32 v16, 16, v63
    v_and_b32 v17, s9, v63
    v_lshlrev_b32 v18, 16, v67
    v_and_b32 v19, s9, v67
    v_lshlrev_b32 v20, 16, v71
    v_and_b32 v21, s9, v71
    v_lshlrev_b32 v22, 16, v75
    v_and_b32 v23, s9, v75
    v_lshlrev_b32 v24, 16, v79
    v_and_b32 v25, s9, v79
    v_lshlrev_b32 v26, 16, v83
    v_and_b32 v27, s9, v83
    v_lshlrev_b32 v28, 16, v87
    v_and_b32 v29, s9, v87
    v_lshlrev_b32 v30, 16, v91
    v_and_b32 v31, s9, v91
    s_waitcnt lgkmcnt(0)
    s_mov_b32 s10, 16384
    buffer_store_dwordx4 v[40:43], v8, s[40:43], s10 offen sc1
    s_mov_b32 s10, 20480
    buffer_store_dwordx4 v[44:47], v8, s[40:43], s10 offen sc1
    v_pk_mul_f32 v[210:211], v[210:211], v[16:17]
    v_pk_mul_f32 v[212:213], v[212:213], v[18:19]
    v_pk_mul_f32 v[214:215], v[214:215], v[20:21]
    v_pk_mul_f32 v[216:217], v[216:217], v[22:23]
    v_pk_mul_f32 v[218:219], v[218:219], v[24:25]
    v_pk_mul_f32 v[220:221], v[220:221], v[26:27]
    v_pk_mul_f32 v[222:223], v[222:223], v[28:29]
    v_pk_mul_f32 v[224:225], v[224:225], v[30:31]
    v_cvt_pk_bf16_f32 v32, v224, v222
    v_cvt_pk_bf16_f32 v33, v220, v218
    v_cvt_pk_bf16_f32 v34, v216, v214
    v_cvt_pk_bf16_f32 v35, v212, v210
    ds_write_b128 v13, v[32:35] offset:0
    v_cvt_pk_bf16_f32 v36, v225, v223
    v_cvt_pk_bf16_f32 v37, v221, v219
    v_cvt_pk_bf16_f32 v38, v217, v215
    v_cvt_pk_bf16_f32 v39, v213, v211
    ds_write_b128 v13, v[36:39] offset:1024
    ds_read_b128 v[40:43], v14 offset:0
    ds_read_b128 v[44:47], v14 offset:1024
    s_waitcnt lgkmcnt(0)
    s_mov_b32 s10, 24576
    buffer_store_dwordx4 v[40:43], v8, s[40:43], s10 offen sc1
    s_mov_b32 s10, 28672
    buffer_store_dwordx4 v[44:47], v8, s[40:43], s10 offen sc1
    s_waitcnt vmcnt(0)
    v_readfirstlane_b32 s56, v236
    v_readfirstlane_b32 s57, v237
    s_nop 0
    s_cmp_lg_u64 s[56:57], 0
    s_cbranch_scc1 TF8
    s_mov_b32 s52, s36
    s_mov_b32 s53, s37
    s_mov_b32 s54, 256
    s_mov_b32 s55, 0x00020000
    v_mov_b32 v238, 0
    s_mov_b32 s58, 0
GT9:
    buffer_load_dwordx2 v[236:237], v238, s[52:55], 0 offen sc1
    s_add_u32 s58, s58, 1
    s_waitcnt vmcnt(0)
    v_readfirstlane_b32 s56, v236
    v_readfirstlane_b32 s57, v237
    s_nop 0
    s_cmp_lg_u64 s[56:57], 0
    s_cbranch_scc1 GD10
    s_cmp_lt_u32 s58, 200000
    s_cbranch_scc1 GT9
GD10:
TF8:
    s_lshl_b32 s9, s6, 5
    s_add_u32 s9, s9, s7
    s_lshl_b32 s9, s9, 7
    s_add_u32 s9, s9, 16809984
    v_mov_b32 v236, s56
    v_mov_b32 v237, s57
    v_mov_b32 v238, 0
    s_mov_b64 exec, 1
    buffer_store_dwordx2 v[236:237], v238, s[40:43], s9 offen sc1
    s_mov_b64 exec, -1
    s_branch G1_DONE
G1_SKIP:
    s_waitcnt lgkmcnt(0)
    s_mov_b32 s40, s38
    s_mov_b32 s41, s39
    s_mov_b32 s42, 17432576
    s_mov_b32 s43, 0x00020000
    v_lshlrev_b32 v20, 7, v1
    s_getpc_b64 s[62:63]
LPC4:
    s_add_u32 s62, s62, M_CONV1-LPC4
    s_addc_u32 s63, s63, 0
    s_bfe_u32 s9, s2, 0x30003
    s_lshl_b32 s9, s9, 11
    v_add_u32 v21, s9, v20
    s_mov_b32 exec_lo, 0xffff
    s_mov_b32 exec_hi, 0
    global_load_dword v252, v21, s[62:63]
    s_mov_b64 exec, -1
    s_getpc_b64 s[58:59]
LPC5:
    s_add_u32 s58, s58, M_TAB-LPC5
    s_addc_u32 s59, s59, 0
    s_load_dwordx16 s[64:79], s[58:59], 0
    s_load_dwordx16 s[80:95], s[58:59], 64
    v_lshlrev_b32 v251, 4, v1
    global_load_dwordx4 v[228:231], v251, s[58:59] offset:128
    global_load_dwordx4 v[232:235], v251, s[58:59] offset:1152
    global_load_dwordx4 v[240:243], v251, s[58:59] offset:2176
    global_load_dwordx4 v[244:247], v251, s[58:59] offset:3200
    s_barrier
    s_mov_b32 s52, s36
    s_mov_b32 s53, s37
    s_mov_b32 s54, 256
    s_mov_b32 s55, 0x00020000
    v_mov_b32 v238, 0
    s_mov_b32 s58, 0
GT11:
    buffer_load_dwordx2 v[236:237], v238, s[52:55], 0 offen sc1
    s_add_u32 s58, s58, 1
    s_waitcnt vmcnt(0)
    v_readfirstlane_b32 s56, v236
    v_readfirstlane_b32 s57, v237
    s_nop 0
    s_cmp_lg_u64 s[56:57], 0
    s_cbranch_scc1 GD12
    s_cmp_lt_u32 s58, 200000
    s_cbranch_scc1 GT11
GD12:
G1_DONE:
    s_barrier
    s_lshl_b32 s28, s4, 2
    s_sub_u32 s28, s28, 128
    s_lshl_b32 s9, s4, 1
    s_add_u32 s9, s9, 126
    s_cmp_ge_u32 s4, 32
    s_cselect_b32 s28, s28, s9
    s_cselect_b32 s9, 0, 4
    s_lshr_b32 s29, s15, 1
    s_add_u32 s28, s28, s29
    s_mov_b32 s101, 0
    s_cmp_lt_u32 s15, s9
    s_cselect_b32 s10, 1, 3
    s_cselect_b32 s29, 0, s29
    s_cbranch_scc1 M_AL
M_CONV1:
    s_and_b32 s16, s15, 1
    v_lshlrev_b32 v118, 4, v1
    s_lshl_b32 s18, s28, 12
    s_add_u32 s26, s18, 10485760
    s_add_u32 s48, s38, s26
    s_addc_u32 s49, s39, 0
    s_mov_b32 s50, 4096
    s_mov_b32 s51, 0x00020000
    s_lshl_b32 s27, s16, 11
    s_mul_i32 s29, s29, 25792
    s_add_u32 s29, s29, 9024
    v_and_b32 v130, 15, v1
    v_lshrrev_b32 v131, 4, v1
    s_sub_u32 s19, 2359296, s18
    s_add_u32 s52, s30, s18
    s_addc_u32 s53, s31, 0
    s_mov_b32 s54, s19
    s_mov_b32 s55, 0x00020000
    s_mul_i32 s24, s16, 4224
    s_add_u32 s24, s24, s29
    s_lshl_b32 s25, s16, 2
    s_add_u32 s25, s25, 4
    s_sub_u32 s26, s16, 15
    v_add_u32 v119, s26, v130
    v_cmp_eq_u32 s[98:99], 0, v119
    v_lshlrev_b32 v119, 2, v119
    s_add_u32 m0, s24, 64
MC_H:
    buffer_load_dword v132, v119, s[52:55], 0 offen
    buffer_load_dwordx4 v118, s[52:55], s25 offen offset:0 lds
    buffer_load_dwordx4 v118, s[52:55], s25 offen offset:1024 lds
    buffer_load_dwordx4 v118, s[52:55], s25 offen offset:2048 lds
    buffer_load_dwordx4 v118, s[52:55], s25 offen offset:3072 lds
MC_H2:
    s_lshr_b32 s26, s28, 6
    s_lshl_b32 s26, s26, 12
    s_add_u32 s26, s26, 16809984
    v_lshl_add_u32 v120, v1, 7, s26
    v_mov_b32 v121, 38976
    s_cmp_eq_u32 s15, 7
    s_cbranch_scc1 MC_P
    s_mov_b32 s58, 0
LW13:
    ds_read_b32 v134, v121 offset:20
    s_add_u32 s58, s58, 1
    s_waitcnt lgkmcnt(0)
    v_readfirstlane_b32 s59, v134
    s_nop 0
    s_cmp_eq_u32 s59, s56
    s_cbranch_scc1 LD14
    s_cmp_lt_u32 s58, 3200000
    s_cbranch_scc1 LW13
LD14:
    s_branch MC_W
MC_P:
    v_mov_b32 v121, 38976
    s_mov_b32 exec_lo, -1
    s_mov_b32 exec_hi, 0
    s_mov_b32 s58, 0
PL15:
    buffer_load_dwordx2 v[134:135], v120, s[40:43], 0 offen sc1
    s_add_u32 s58, s58, 1
    s_waitcnt vmcnt(0)
    v_cmp_ne_u64 vcc, s[56:57], v[134:135]
    s_nop 4
    s_cbranch_vccz PD16
    s_cmp_lt_u32 s58, 200000
    s_cbranch_scc1 PL15
PD16:
    s_mov_b64 exec, -1
    v_mov_b32 v134, s56
    ds_write_b32 v121, v134 offset:20
MC_W:
    buffer_load_dwordx4 v[136:139], v118, s[48:51], s27 offen offset:0 sc1
    buffer_load_dwordx4 v[140:143], v118, s[48:51], s27 offen offset:4 sc1
    buffer_load_dwordx4 v[144:147], v118, s[48:51], s27 offen offset:1024 sc1
    buffer_load_dwordx4 v[148:151], v118, s[48:51], s27 offen offset:1028 sc1
MC_HAVEU:
    s_lshr_b32 s17, s28, 1
    s_lshl_b32 s17, s17, 2
    s_load_dword s63, s[32:33], s17
    s_lshl_b32 s25, s28, 1
    s_add_u32 s25, s25, s16
    s_lshl_b32 s25, s25, 7
    s_add_u32 s101, s25, 16908288
    s_branch M_APREP
M_AL:
    s_and_b32 s14, s2, 7
    s_lshl_b32 s14, s14, 2
    s_bfe_u32 s0, s2, 0x20003
    s_add_u32 s14, s14, s0
    s_lshr_b32 s0, s2, 5
    s_add_u32 s0, s0, 1
    s_and_b32 s0, s0, 7
    s_lshl_b32 s1, s0, 3
    s_lshl_b32 s48, s14, 6
    s_add_u32 s48, s48, s1
    s_lshl_b32 s48, s48, 10
    s_add_u32 s49, s48, 2613248
    s_lshr_b32 s50, s14, 1
    s_lshl_b32 s50, s50, 6
    s_add_u32 s50, s50, s1
    s_lshl_b32 s50, s50, 8
    s_add_u32 s51, s50, 2357248
    s_add_u32 s50, s50, 2097152
    s_lshr_b32 s62, s14, 3
    s_lshl_b32 s98, s62, 6
    s_add_u32 s98, s98, s1
    s_mul_i32 s98, s98, 9216
    s_and_b32 s99, s14, 7
    s_mul_i32 s99, s99, 288
    s_add_u32 s98, s98, s99
    s_add_u32 s98, s98, 4644864
    v_lshlrev_b32 v130, 4, v1
    v_add_u32 v136, 0, v1
    v_mul_u32_u24 v136, 57, v136
    v_lshrrev_b32 v136, 10, v136
    v_mul_u32_u24 v136, 2016, v136
    v_add_u32 v131, v136, v130
    v_add_u32 v136, 64, v1
    v_mul_u32_u24 v136, 57, v136
    v_lshrrev_b32 v136, 10, v136
    v_mul_u32_u24 v136, 2016, v136
    v_add_u32 v132, v136, v130
    v_add_u32 v136, 128, v1
    v_mul_u32_u24 v136, 57, v136
    v_lshrrev_b32 v136, 10, v136
    v_mul_u32_u24 v136, 2016, v136
    v_add_u32 v133, v136, v130
    v_add_u32 v136, 192, v1
    v_mul_u32_u24 v136, 57, v136
    v_lshrrev_b32 v136, 10, v136
    v_mul_u32_u24 v136, 2016, v136
    v_add_u32 v134, v136, v130
    v_add_u32 v136, 256, v1
    v_mul_u32_u24 v136, 57, v136
    v_lshrrev_b32 v136, 10, v136
    v_mul_u32_u24 v136, 2016, v136
    v_add_u32 v135, v136, v130
    v_add_u32 v135, 4096, v135
    s_sub_u32 s1, 3, s15
    s_lshl_b32 s99, s0, 1
    s_lshl_b32 s62, s62, 4
    s_add_u32 s62, s62, s99
    s_add_u32 s99, s62, s1
    s_add_u32 s99, s99, 62
    v_lshl_add_u32 v136, v1, 6, s99
    s_lshr_b32 s99, s1, 1
    s_add_u32 s99, s99, s62
    v_writelane_b32 v136, s99, 2
    v_lshlrev_b32 v136, 7, v136
    v_add_u32 v136, 16777216, v136
    s_lshr_b32 s62, s1, 1
    s_or_b32 s62, s62, s0
    v_mov_b32 v137, 38976
    s_cmp_ge_u32 s2, 192
    s_cbranch_scc1 MA_NOPUB
    v_lshl_add_u32 v138, s3, 2, v137
    s_waitcnt vmcnt(0)
    v_mov_b32 v139, s56
    ds_write_b32 v138, v139
    s_cmp_lg_u32 s3, 0
    s_cbranch_scc1 MA_NOPUB1
    s_mov_b32 s58, 0
LW17:
    ds_read_b32 v138, v137 offset:4
    s_add_u32 s58, s58, 1
    s_waitcnt lgkmcnt(0)
    v_readfirstlane_b32 s59, v138
    s_nop 0
    s_cmp_eq_u32 s59, s56
    s_cbranch_scc1 LD18
    s_cmp_lt_u32 s58, 3200000
    s_cbranch_scc1 LW17
LD18:
    s_mov_b32 s58, 0
LW19:
    ds_read_b32 v138, v137 offset:8
    s_add_u32 s58, s58, 1
    s_waitcnt lgkmcnt(0)
    v_readfirstlane_b32 s59, v138
    s_nop 0
    s_cmp_eq_u32 s59, s56
    s_cbranch_scc1 LD20
    s_cmp_lt_u32 s58, 3200000
    s_cbranch_scc1 LW19
LD20:
    s_mov_b32 s58, 0
LW21:
    ds_read_b32 v138, v137 offset:12
    s_add_u32 s58, s58, 1
    s_waitcnt lgkmcnt(0)
    v_readfirstlane_b32 s59, v138
    s_nop 0
    s_cmp_eq_u32 s59, s56
    s_cbranch_scc1 LD22
    s_cmp_lt_u32 s58, 3200000
    s_cbranch_scc1 LW21
LD22:
    v_mov_b32 v138, s56
    v_mov_b32 v139, s57
    v_mov_b32 v140, 0
    s_mov_b64 exec, 1
    buffer_store_dwordx2 v[138:139], v140, s[40:43], s63 offen sc1
    s_mov_b64 exec, -1
    s_branch MA_NOPUB
MA_NOPUB1:
    s_mov_b32 s58, 0
LW23:
    ds_read_b32 v138, v137 offset:32
    s_add_u32 s58, s58, 1
    s_waitcnt lgkmcnt(0)
    v_readfirstlane_b32 s59, v138
    s_nop 0
    s_cmp_eq_u32 s59, s56
    s_cbranch_scc1 LD24
    s_cmp_lt_u32 s58, 3200000
    s_cbranch_scc1 LW23
LD24:
    s_mov_b32 s58, 0
LW25:
    ds_read_b32 v138, v137 offset:36
    s_add_u32 s58, s58, 1
    s_waitcnt lgkmcnt(0)
    v_readfirstlane_b32 s59, v138
    s_nop 0
    s_cmp_eq_u32 s59, s56
    s_cbranch_scc1 LD26
    s_cmp_lt_u32 s58, 3200000
    s_cbranch_scc1 LW25
LD26:
    s_mov_b32 s58, 0
LW27:
    ds_read_b32 v138, v137 offset:40
    s_add_u32 s58, s58, 1
    s_waitcnt lgkmcnt(0)
    v_readfirstlane_b32 s59, v138
    s_nop 0
    s_cmp_eq_u32 s59, s56
    s_cbranch_scc1 LD28
    s_cmp_lt_u32 s58, 3200000
    s_cbranch_scc1 LW27
LD28:
    s_mov_b32 s58, 0
LW29:
    ds_read_b32 v138, v137 offset:44
    s_add_u32 s58, s58, 1
    s_waitcnt lgkmcnt(0)
    v_readfirstlane_b32 s59, v138
    s_nop 0
    s_cmp_eq_u32 s59, s56
    s_cbranch_scc1 LD30
    s_cmp_lt_u32 s58, 3200000
    s_cbranch_scc1 LW29
LD30:
MA_NOPUB:
    s_cmp_eq_u32 s62, 0
    s_cselect_b32 s99, 4, 7
    s_mov_b32 exec_lo, s99
    s_mov_b32 exec_hi, 0
    s_mov_b32 s58, 0
PL31:
    buffer_load_dwordx2 v[138:139], v136, s[40:43], 0 offen sc1
    s_add_u32 s58, s58, 1
    s_waitcnt vmcnt(0)
    v_cmp_ne_u64 vcc, s[56:57], v[138:139]
    s_nop 4
    s_cbranch_vccz PD32
    s_cmp_lt_u32 s58, 200000
    s_cbranch_scc1 PL31
PD32:
    s_mov_b64 exec, -1
    s_lshl_b32 s58, s1, 11
    s_add_u32 m0, s58, 153600
    s_add_u32 s59, s48, s58
    buffer_load_dwordx4 v130, s[40:43], s59 offen offset:0 sc1 lds
    buffer_load_dwordx4 v130, s[40:43], s59 offen offset:1024 sc1 lds
    s_lshl_b32 s58, s1, 9
    s_add_u32 m0, s58, 161792
    s_add_u32 s59, s50, s58
    s_mov_b32 exec_hi, 0
    buffer_load_dwordx4 v130, s[40:43], s59 offen sc1 lds
    s_mov_b32 exec_hi, -1
    s_cmp_eq_u32 s62, 0
    s_cbranch_scc1 MA_NEXT
    s_lshl_b32 s58, s1, 12
    s_add_u32 m0, s58, 114688
    s_add_u32 s59, s49, s58
    buffer_load_dwordx4 v130, s[40:43], s59 offen offset:0 sc1 lds
    buffer_load_dwordx4 v130, s[40:43], s59 offen offset:1024 sc1 lds
    buffer_load_dwordx4 v130, s[40:43], s59 offen offset:2048 sc1 lds
    buffer_load_dwordx4 v130, s[40:43], s59 offen offset:3072 sc1 lds
    s_lshl_b32 s58, s1, 10
    s_add_u32 m0, s58, 149504
    s_add_u32 s59, s51, s58
    buffer_load_dwordx4 v130, s[40:43], s59 offen sc1 lds
    s_mul_i32 s58, s1, 4608
    s_add_u32 m0, s58, 131072
    s_mul_i32 s59, s1, 36864
    s_add_u32 s59, s59, s98
    buffer_load_dwordx4 v131, s[40:43], s59 offen offset:0 sc1 lds
    buffer_load_dwordx4 v132, s[40:43], s59 offen offset:1024 sc1 lds
    buffer_load_dwordx4 v133, s[40:43], s59 offen offset:2048 sc1 lds
    buffer_load_dwordx4 v134, s[40:43], s59 offen offset:3072 sc1 lds
    s_add_u32 m0, s58, 135168
    s_mov_b32 exec_hi, 0
    buffer_load_dwordx4 v135, s[40:43], s59 offen sc1 lds
    s_mov_b32 exec_hi, -1
MA_NEXT:
M_APREP:
    s_lshr_b32 s60, s2, 5
    s_mul_i32 s60, s60, 192
    s_mul_i32 s62, s3, 20736
    s_add_u32 s62, s62, s60
    s_mul_i32 s6, s3, 145152
    s_add_u32 s1, s62, s6
    s_mul_i32 s61, s3, 3072
    s_mov_b32 s44, s20
    s_mov_b32 s45, s21
    s_mov_b32 s46, 663552
    s_mov_b32 s47, 0x00020000
    s_and_b32 s14, s2, 7
    s_lshl_b32 s14, s14, 2
    s_bfe_u32 s5, s2, 0x20003
    s_add_u32 s14, s14, s5
    s_lshr_b32 s5, s2, 5
    s_add_u32 s5, s5, 1
    s_and_b32 s5, s5, 7
    s_lshl_b32 s5, s5, 3
    s_sub_u32 s59, 7, s15
    s_cmp_lt_u32 s15, 4
    s_cselect_b32 s59, s59, s3
    s_add_u32 s5, s5, s59
    v_and_b32 v8, 31, v1
    v_lshrrev_b32 v9, 5, v1
    s_lshl_b32 s6, s59, 10
    s_add_u32 s6, s6, 114688
    v_lshl_add_u32 v2, v1, 4, s6
    s_and_b32 s7, s14, 1
    s_lshl_b32 s7, s7, 2
    s_lshl_b32 s8, s59, 8
    s_add_u32 s7, s7, s8
    s_add_u32 s7, s7, 114688
    v_add_u32 v3, s7, v246
    s_mul_i32 s6, s59, 1152
    s_add_u32 s6, s6, 131072
    v_add_u32 v4, s6, v247
    v_mov_b32 v36, 0x3f803f80
    v_mov_b32 v37, 0x3f803f80
    v_mov_b32 v38, 0x3f803f80
    v_mov_b32 v39, 0x3f803f80
    v_mov_b32 v40, 0x3f803f80
    v_mov_b32 v41, 0x3f803f80
    v_mov_b32 v42, 0x3f803f80
    v_mov_b32 v43, 0x3f803f80
    v_mov_b32 v44, 0x3f803f80
    v_mov_b32 v45, 0x3f803f80
    v_mov_b32 v46, 0x3f803f80
    v_mov_b32 v47, 0x3f803f80
    v_mov_b32 v48, 0x3f803f80
    v_mov_b32 v49, 0x3f803f80
    v_mov_b32 v50, 0x3f803f80
    v_mov_b32 v51, 0x3f803f80
    s_mov_b32 s8, 0x3ffff
    s_mov_b32 s9, 0x3ffff
    v_lshrrev_b32 v5, 4, v8
    v_lshlrev_b32 v5, 14, v5
    v_lshl_add_u32 v5, v9, 8, v5
    v_and_b32 v6, 15, v8
    v_lshl_add_u32 v5, v6, 4, v5
    v_lshlrev_b32 v6, 2, v8
    s_lshl_b32 s12, s5, 15
    s_lshl_b32 s13, s14, 9
    s_add_u32 s12, s12, s13
    s_add_u32 s12, s12, 7340032
    s_lshl_b32 s13, s14, 13
    s_lshl_b32 s6, s5, 7
    s_add_u32 s13, s13, s6
    s_add_u32 s13, s13, 9437184
    v_cmp_gt_u32 vcc, 32, v1
    v_mov_b32 v248, 0x3f803f80
    v_mov_b32 v249, 0x3f80
    v_cndmask_b32 v25, 0, v248, vcc
    v_cndmask_b32 v26, 0, v249, vcc
    v_mov_b32 v27, 0
    v_cndmask_b32 v33, 0, v248, vcc
    v_cndmask_b32 v34, 0, v249, vcc
    v_mov_b32 v35, 0
    v_mov_b32 v16, 0
    v_mov_b32 v18, 0
    v_mov_b32 v19, 0
    v_mov_b32 v116, 0x7b800000
    s_mov_b32 s100, 0
    s_mov_b32 s6, 0x21800000
    s_lshr_b32 s60, s15, 2
    s_cmp_ge_u32 s2, 192
    s_cselect_b32 s60, 13, s60
    v_lshlrev_b32 v117, 2, v1
    v_add_u32 v117, 112640, v117
    s_lshl_b32 s7, s15, 2
    s_add_u32 s7, s7, 112640
    v_mov_b32 v239, s7
    s_lshr_b32 s7, s5, 3
    s_lshl_b32 s7, s7, 5
    s_add_u32 s7, s7, s14
    s_lshl_b32 s7, s7, 7
    s_add_u32 s7, s7, 17170432
    s_cmp_lt_u32 s10, 2
    s_cbranch_scc1 MT_ALW
    v_lshlrev_b32 v118, 4, v1
    v_lshl_add_u32 v120, v130, 2, s24
    s_mul_i32 s26, s16, 4576
    s_add_u32 s26, s26, s29
    v_add_u32 v123, s26, v118
    v_mov_b32 v152, 0
    v_mov_b32 v153, 0
    v_mov_b32 v154, 0
    v_mov_b32 v155, 0
    s_mov_b32 exec_lo, 0x3fffffff
    s_mov_b32 exec_hi, 0
    ds_write_b128 v123, v[152:155] offset:12544
    s_mov_b64 exec, -1
    s_add_u32 s26, s29, s27
    v_add_u32 v123, s26, v118
    v_and_b32 v122, 1, v130
    v_mul_u32_u24 v121, 4224, v122
    v_lshrrev_b32 v124, 1, v130
    v_lshl_add_u32 v121, v124, 3, v121
    v_lshl_add_u32 v121, v131, 4, v121
    s_lshl_b32 s26, s16, 8
    s_add_u32 s26, s26, s29
    v_add_u32 v121, s26, v121
    v_mul_u32_u24 v122, 4576, v122
    v_lshlrev_b32 v124, 6, v124
    v_sub_u32 v122, v122, v124
    v_lshl_add_u32 v122, v131, 4, v122
    s_add_u32 s26, s26, 8896
    v_add_u32 v122, s26, v122
    s_lshl_b32 s26, s16, 12
    s_add_u32 s26, s26, s29
    s_add_u32 s26, s26, 17600
    v_add_u32 v124, s26, v118
    s_xor_b32 s0, s16, 1
    s_lshl_b32 s26, s0, 12
    s_add_u32 s26, s26, s29
    s_add_u32 s26, s26, 17600
    v_add_u32 v126, s26, v118
    v_lshlrev_b32 v125, 7, v131
    v_lshl_add_u32 v125, v130, 2, v125
    v_add_u32 v125, s26, v125
    s_add_u32 s27, s18, s27
    s_add_u32 s27, s27, 13631488
    s_lshl_b32 s26, s16, 2
    s_add_u32 s26, s26, s29
    s_add_u32 s26, s26, 8384
    v_mov_b32 v127, s26
    v_xor_b32 v128, 4, v127
    s_waitcnt vmcnt(0) lgkmcnt(0)
    s_and_b32 s26, s28, 1
    s_cmp_eq_u32 s26, 0
    s_cselect_b32 s26, 16, 0
    s_lshl_b32 s63, s63, s26
    s_and_b32 s63, s63, 0xffff0000
    v_lshlrev_b32 v133, 16, v132
    v_and_b32 v134, 0xffff0000, v132
    v_add_f32 v133, s63, v133
    v_cvt_pk_bf16_f32 v133, v133, v134
    v_cndmask_b32 v132, v132, v133, s[98:99]
    s_mov_b32 exec_lo, 0xffff
    s_mov_b32 exec_hi, 0
    ds_write_b32 v120, v132
    s_mov_b64 exec, -1
    ds_write_b128 v123, v[136:139] offset:13024
    v_alignbit_b32 v140, v140, v136, 16
    v_alignbit_b32 v141, v141, v137, 16
    v_alignbit_b32 v142, v142, v138, 16
    v_alignbit_b32 v143, v143, v139, 16
    ds_write_b128 v123, v[140:143] offset:8448
    ds_write_b128 v123, v[144:147] offset:14048
    v_alignbit_b32 v148, v148, v144, 16
    v_alignbit_b32 v149, v149, v145, 16
    v_alignbit_b32 v150, v150, v146, 16
    v_alignbit_b32 v151, v151, v147, 16
    ds_write_b128 v123, v[148:151] offset:9472
    v_mov_b32 v129, s56
    s_waitcnt lgkmcnt(0)
    ds_write_b32 v127, v129
    s_mov_b32 s58, 0
LW33:
    ds_read_b32 v132, v128 offset:0
    s_add_u32 s58, s58, 1
    s_waitcnt lgkmcnt(0)
    v_readfirstlane_b32 s59, v132
    s_nop 0
    s_cmp_eq_u32 s59, s56
    s_cbranch_scc1 LD34
    s_cmp_lt_u32 s58, 3200000
    s_cbranch_scc1 LW33
LD34:
    ds_read_b64 v[132:133], v121 offset:0
    ds_read_b64 v[134:135], v121 offset:8
    ds_read_b128 v[192:195], v122 offset:0
    ds_read_b128 v[188:191], v122 offset:512
    ds_read_b128 v[184:187], v122 offset:1024
    ds_read_b128 v[180:183], v122 offset:1536
    ds_read_b128 v[176:179], v122 offset:2048
    ds_read_b128 v[172:175], v122 offset:2560
    ds_read_b128 v[168:171], v122 offset:3072
    ds_read_b128 v[164:167], v122 offset:3584
    ds_read_b64 v[136:137], v121 offset:512
    ds_read_b64 v[138:139], v121 offset:520
    ds_read_b64 v[140:141], v121 offset:1024
    ds_read_b64 v[142:143], v121 offset:1032
    s_waitcnt lgkmcnt(11)
    v_mfma_f32_16x16x32_bf16 v[224:227], v[192:195], v[132:135], 0
    ds_read_b128 v[192:195], v122 offset:64
    s_waitcnt lgkmcnt(11)
    v_mfma_f32_16x16x32_bf16 v[220:223], v[188:191], v[132:135], 0
    ds_read_b64 v[144:145], v121 offset:1536
    s_waitcnt lgkmcnt(11)
    v_mfma_f32_16x16x32_bf16 v[216:219], v[184:187], v[132:135], 0
    ds_read_b64 v[146:147], v121 offset:1544
    s_waitcnt lgkmcnt(11)
    v_mfma_f32_16x16x32_bf16 v[212:215], v[180:183], v[132:135], 0
    ds_read_b64 v[148:149], v121 offset:2048
    s_waitcnt lgkmcnt(11)
    v_mfma_f32_16x16x32_bf16 v[208:211], v[176:179], v[132:135], 0
    ds_read_b64 v[150:151], v121 offset:2056
    s_waitcnt lgkmcnt(11)
    v_mfma_f32_16x16x32_bf16 v[204:207], v[172:175], v[132:135], 0
    ds_read_b64 v[152:153], v121 offset:2560
    s_waitcnt lgkmcnt(11)
    v_mfma_f32_16x16x32_bf16 v[200:203], v[168:171], v[132:135], 0
    ds_read_b64 v[154:155], v121 offset:2568
    s_waitcnt lgkmcnt(11)
    v_mfma_f32_16x16x32_bf16 v[196:199], v[164:167], v[132:135], 0
    ds_read_b64 v[156:157], v121 offset:3072
    s_waitcnt lgkmcnt(10)
    v_mfma_f32_16x16x32_bf16 v[224:227], v[188:191], v[136:139], v[224:227]
    ds_read_b128 v[188:191], v122 offset:576
    v_mfma_f32_16x16x32_bf16 v[220:223], v[184:187], v[136:139], v[220:223]
    ds_read_b64 v[158:159], v121 offset:3080
    v_mfma_f32_16x16x32_bf16 v[216:219], v[180:183], v[136:139], v[216:219]
    ds_read_b64 v[160:161], v121 offset:3584
    v_mfma_f32_16x16x32_bf16 v[212:215], v[176:179], v[136:139], v[212:215]
    ds_read_b64 v[162:163], v121 offset:3592
    v_mfma_f32_16x16x32_bf16 v[208:211], v[172:175], v[136:139], v[208:211]
    v_mfma_f32_16x16x32_bf16 v[204:207], v[168:171], v[136:139], v[204:207]
    v_mfma_f32_16x16x32_bf16 v[200:203], v[164:167], v[136:139], v[200:203]
    s_waitcnt lgkmcnt(12)
    v_mfma_f32_16x16x32_bf16 v[224:227], v[184:187], v[140:143], v[224:227]
    ds_read_b128 v[184:187], v122 offset:1088
    v_mfma_f32_16x16x32_bf16 v[220:223], v[180:183], v[140:143], v[220:223]
    ds_read_b64 v[132:133], v121 offset:64
    v_mfma_f32_16x16x32_bf16 v[216:219], v[176:179], v[140:143], v[216:219]
    v_mfma_f32_16x16x32_bf16 v[212:215], v[172:175], v[140:143], v[212:215]
    v_mfma_f32_16x16x32_bf16 v[208:211], v[168:171], v[140:143], v[208:211]
    v_mfma_f32_16x16x32_bf16 v[204:207], v[164:167], v[140:143], v[204:207]
    s_waitcnt lgkmcnt(11)
    v_mfma_f32_16x16x32_bf16 v[224:227], v[180:183], v[144:147], v[224:227]
    ds_read_b128 v[180:183], v122 offset:1600
    v_mfma_f32_16x16x32_bf16 v[220:223], v[176:179], v[144:147], v[220:223]
    ds_read_b64 v[134:135], v121 offset:72
    v_mfma_f32_16x16x32_bf16 v[216:219], v[172:175], v[144:147], v[216:219]
    ds_read_b64 v[136:137], v121 offset:576
    v_mfma_f32_16x16x32_bf16 v[212:215], v[168:171], v[144:147], v[212:215]
    v_mfma_f32_16x16x32_bf16 v[208:211], v[164:167], v[144:147], v[208:211]
    s_waitcnt lgkmcnt(12)
    v_mfma_f32_16x16x32_bf16 v[224:227], v[176:179], v[148:151], v[224:227]
    ds_read_b128 v[176:179], v122 offset:2112
    v_mfma_f32_16x16x32_bf16 v[220:223], v[172:175], v[148:151], v[220:223]
    ds_read_b64 v[138:139], v121 offset:584
    v_mfma_f32_16x16x32_bf16 v[216:219], v[168:171], v[148:151], v[216:219]
    v_mfma_f32_16x16x32_bf16 v[212:215], v[164:167], v[148:151], v[212:215]
    s_waitcnt lgkmcnt(12)
    v_mfma_f32_16x16x32_bf16 v[224:227], v[172:175], v[152:155], v[224:227]
    ds_read_b128 v[172:175], v122 offset:2624
    v_mfma_f32_16x16x32_bf16 v[220:223], v[168:171], v[152:155], v[220:223]
    ds_read_b64 v[140:141], v121 offset:1088
    v_mfma_f32_16x16x32_bf16 v[216:219], v[164:167], v[152:155], v[216:219]
    s_waitcnt lgkmcnt(11)
    v_mfma_f32_16x16x32_bf16 v[224:227], v[168:171], v[156:159], v[224:227]
    ds_read_b128 v[168:171], v122 offset:3136
    v_mfma_f32_16x16x32_bf16 v[220:223], v[164:167], v[156:159], v[220:223]
    ds_read_b64 v[142:143], v121 offset:1096
    s_waitcnt lgkmcnt(11)
    v_mfma_f32_16x16x32_bf16 v[224:227], v[164:167], v[160:163], v[224:227]
    ds_read_b128 v[164:167], v122 offset:3648
    s_waitcnt lgkmcnt(8)
    v_mfma_f32_16x16x32_bf16 v[224:227], v[192:195], v[132:135], v[224:227]
    ds_read_b128 v[192:195], v122 offset:128
    v_mfma_f32_16x16x32_bf16 v[220:223], v[188:191], v[132:135], v[220:223]
    ds_read_b64 v[144:145], v121 offset:1600
    v_mfma_f32_16x16x32_bf16 v[216:219], v[184:187], v[132:135], v[216:219]
    ds_read_b64 v[146:147], v121 offset:1608
    v_mfma_f32_16x16x32_bf16 v[212:215], v[180:183], v[132:135], v[212:215]
    ds_read_b64 v[148:149], v121 offset:2112
    s_waitcnt lgkmcnt(10)
    v_mfma_f32_16x16x32_bf16 v[208:211], v[176:179], v[132:135], v[208:211]
    ds_read_b64 v[150:151], v121 offset:2120
    s_waitcnt lgkmcnt(9)
    v_mfma_f32_16x16x32_bf16 v[204:207], v[172:175], v[132:135], v[204:207]
    ds_read_b64 v[152:153], v121 offset:2624
    s_waitcnt lgkmcnt(8)
    v_mfma_f32_16x16x32_bf16 v[200:203], v[168:171], v[132:135], v[200:203]
    ds_read_b64 v[154:155], v121 offset:2632
    s_waitcnt lgkmcnt(7)
    v_mfma_f32_16x16x32_bf16 v[196:199], v[164:167], v[132:135], v[196:199]
    ds_read_b64 v[156:157], v121 offset:3136
    v_mfma_f32_16x16x32_bf16 v[224:227], v[188:191], v[136:139], v[224:227]
    ds_read_b128 v[188:191], v122 offset:640
    v_mfma_f32_16x16x32_bf16 v[220:223], v[184:187], v[136:139], v[220:223]
    ds_read_b64 v[158:159], v121 offset:3144
    v_mfma_f32_16x16x32_bf16 v[216:219], v[180:183], v[136:139], v[216:219]
    ds_read_b64 v[160:161], v121 offset:3648
    v_mfma_f32_16x16x32_bf16 v[212:215], v[176:179], v[136:139], v[212:215]
    ds_read_b64 v[162:163], v121 offset:3656
    v_mfma_f32_16x16x32_bf16 v[208:211], v[172:175], v[136:139], v[208:211]
    ds_read_b64 v[132:133], v121 offset:128
    v_mfma_f32_16x16x32_bf16 v[204:207], v[168:171], v[136:139], v[204:207]
    ds_read_b64 v[134:135], v121 offset:136
    v_mfma_f32_16x16x32_bf16 v[200:203], v[164:167], v[136:139], v[200:203]
    v_mfma_f32_16x16x32_bf16 v[224:227], v[184:187], v[140:143], v[224:227]
    v_mfma_f32_16x16x32_bf16 v[220:223], v[180:183], v[140:143], v[220:223]
    v_mfma_f32_16x16x32_bf16 v[216:219], v[176:179], v[140:143], v[216:219]
    v_mfma_f32_16x16x32_bf16 v[212:215], v[172:175], v[140:143], v[212:215]
    v_mfma_f32_16x16x32_bf16 v[208:211], v[168:171], v[140:143], v[208:211]
    v_mfma_f32_16x16x32_bf16 v[204:207], v[164:167], v[140:143], v[204:207]
    s_waitcnt lgkmcnt(11)
    v_mfma_f32_16x16x32_bf16 v[224:227], v[180:183], v[144:147], v[224:227]
    ds_read_b128 v[180:183], v122 offset:1664
    v_mfma_f32_16x16x32_bf16 v[220:223], v[176:179], v[144:147], v[220:223]
    ds_read_b128 v[184:187], v122 offset:1152
    v_mfma_f32_16x16x32_bf16 v[216:219], v[172:175], v[144:147], v[216:219]
    ds_read_b64 v[136:137], v121 offset:640
    v_mfma_f32_16x16x32_bf16 v[212:215], v[168:171], v[144:147], v[212:215]
    v_mfma_f32_16x16x32_bf16 v[208:211], v[164:167], v[144:147], v[208:211]
    s_waitcnt lgkmcnt(12)
    v_mfma_f32_16x16x32_bf16 v[224:227], v[176:179], v[148:151], v[224:227]
    ds_read_b128 v[176:179], v122 offset:2176
    v_mfma_f32_16x16x32_bf16 v[220:223], v[172:175], v[148:151], v[220:223]
    ds_read_b64 v[138:139], v121 offset:648
    v_mfma_f32_16x16x32_bf16 v[216:219], v[168:171], v[148:151], v[216:219]
    v_mfma_f32_16x16x32_bf16 v[212:215], v[164:167], v[148:151], v[212:215]
    s_waitcnt lgkmcnt(12)
    v_mfma_f32_16x16x32_bf16 v[224:227], v[172:175], v[152:155], v[224:227]
    ds_read_b128 v[172:175], v122 offset:2688
    v_mfma_f32_16x16x32_bf16 v[220:223], v[168:171], v[152:155], v[220:223]
    ds_read_b64 v[140:141], v121 offset:1152
    v_mfma_f32_16x16x32_bf16 v[216:219], v[164:167], v[152:155], v[216:219]
    s_waitcnt lgkmcnt(11)
    v_mfma_f32_16x16x32_bf16 v[224:227], v[168:171], v[156:159], v[224:227]
    ds_read_b128 v[168:171], v122 offset:3200
    v_mfma_f32_16x16x32_bf16 v[220:223], v[164:167], v[156:159], v[220:223]
    ds_read_b64 v[142:143], v121 offset:1160
    s_waitcnt lgkmcnt(11)
    v_mfma_f32_16x16x32_bf16 v[224:227], v[164:167], v[160:163], v[224:227]
    ds_read_b128 v[164:167], v122 offset:3712
    s_waitcnt lgkmcnt(10)
    v_mfma_f32_16x16x32_bf16 v[224:227], v[192:195], v[132:135], v[224:227]
    ds_read_b128 v[192:195], v122 offset:192
    v_mfma_f32_16x16x32_bf16 v[220:223], v[188:191], v[132:135], v[220:223]
    ds_read_b64 v[144:145], v121 offset:1664
    s_waitcnt lgkmcnt(10)
    v_mfma_f32_16x16x32_bf16 v[216:219], v[184:187], v[132:135], v[216:219]
    ds_read_b64 v[146:147], v121 offset:1672
    v_mfma_f32_16x16x32_bf16 v[212:215], v[180:183], v[132:135], v[212:215]
    ds_read_b64 v[148:149], v121 offset:2176
    s_waitcnt lgkmcnt(10)
    v_mfma_f32_16x16x32_bf16 v[208:211], v[176:179], v[132:135], v[208:211]
    ds_read_b64 v[150:151], v121 offset:2184
    s_waitcnt lgkmcnt(9)
    v_mfma_f32_16x16x32_bf16 v[204:207], v[172:175], v[132:135], v[204:207]
    ds_read_b64 v[152:153], v121 offset:2688
    s_waitcnt lgkmcnt(8)
    v_mfma_f32_16x16x32_bf16 v[200:203], v[168:171], v[132:135], v[200:203]
    ds_read_b64 v[154:155], v121 offset:2696
    s_waitcnt lgkmcnt(7)
    v_mfma_f32_16x16x32_bf16 v[196:199], v[164:167], v[132:135], v[196:199]
    ds_read_b64 v[156:157], v121 offset:3200
    v_mfma_f32_16x16x32_bf16 v[224:227], v[188:191], v[136:139], v[224:227]
    ds_read_b128 v[188:191], v122 offset:704
    v_mfma_f32_16x16x32_bf16 v[220:223], v[184:187], v[136:139], v[220:223]
    ds_read_b64 v[158:159], v121 offset:3208
    v_mfma_f32_16x16x32_bf16 v[216:219], v[180:183], v[136:139], v[216:219]
    ds_read_b64 v[160:161], v121 offset:3712
    v_mfma_f32_16x16x32_bf16 v[212:215], v[176:179], v[136:139], v[212:215]
    ds_read_b64 v[162:163], v121 offset:3720
    v_mfma_f32_16x16x32_bf16 v[208:211], v[172:175], v[136:139], v[208:211]
    ds_read_b64 v[132:133], v121 offset:192
    v_mfma_f32_16x16x32_bf16 v[204:207], v[168:171], v[136:139], v[204:207]
    ds_read_b64 v[134:135], v121 offset:200
    v_mfma_f32_16x16x32_bf16 v[200:203], v[164:167], v[136:139], v[200:203]
    v_mfma_f32_16x16x32_bf16 v[224:227], v[184:187], v[140:143], v[224:227]
    v_mfma_f32_16x16x32_bf16 v[220:223], v[180:183], v[140:143], v[220:223]
    v_mfma_f32_16x16x32_bf16 v[216:219], v[176:179], v[140:143], v[216:219]
    v_mfma_f32_16x16x32_bf16 v[212:215], v[172:175], v[140:143], v[212:215]
    v_mfma_f32_16x16x32_bf16 v[208:211], v[168:171], v[140:143], v[208:211]
    v_mfma_f32_16x16x32_bf16 v[204:207], v[164:167], v[140:143], v[204:207]
    s_waitcnt lgkmcnt(11)
    v_mfma_f32_16x16x32_bf16 v[224:227], v[180:183], v[144:147], v[224:227]
    ds_read_b128 v[180:183], v122 offset:1728
    v_mfma_f32_16x16x32_bf16 v[220:223], v[176:179], v[144:147], v[220:223]
    ds_read_b128 v[184:187], v122 offset:1216
    v_mfma_f32_16x16x32_bf16 v[216:219], v[172:175], v[144:147], v[216:219]
    ds_read_b64 v[136:137], v121 offset:704
    v_mfma_f32_16x16x32_bf16 v[212:215], v[168:171], v[144:147], v[212:215]
    v_mfma_f32_16x16x32_bf16 v[208:211], v[164:167], v[144:147], v[208:211]
    s_waitcnt lgkmcnt(12)
    v_mfma_f32_16x16x32_bf16 v[224:227], v[176:179], v[148:151], v[224:227]
    ds_read_b128 v[176:179], v122 offset:2240
    v_mfma_f32_16x16x32_bf16 v[220:223], v[172:175], v[148:151], v[220:223]
    ds_read_b64 v[138:139], v121 offset:712
    v_mfma_f32_16x16x32_bf16 v[216:219], v[168:171], v[148:151], v[216:219]
    v_mfma_f32_16x16x32_bf16 v[212:215], v[164:167], v[148:151], v[212:215]
    s_waitcnt lgkmcnt(12)
    v_mfma_f32_16x16x32_bf16 v[224:227], v[172:175], v[152:155], v[224:227]
    ds_read_b128 v[172:175], v122 offset:2752
    v_mfma_f32_16x16x32_bf16 v[220:223], v[168:171], v[152:155], v[220:223]
    ds_read_b64 v[140:141], v121 offset:1216
    v_mfma_f32_16x16x32_bf16 v[216:219], v[164:167], v[152:155], v[216:219]
    s_waitcnt lgkmcnt(11)
    v_mfma_f32_16x16x32_bf16 v[224:227], v[168:171], v[156:159], v[224:227]
    ds_read_b128 v[168:171], v122 offset:3264
    v_mfma_f32_16x16x32_bf16 v[220:223], v[164:167], v[156:159], v[220:223]
    ds_read_b64 v[142:143], v121 offset:1224
    s_waitcnt lgkmcnt(11)
    v_mfma_f32_16x16x32_bf16 v[224:227], v[164:167], v[160:163], v[224:227]
    ds_read_b128 v[164:167], v122 offset:3776
    s_waitcnt lgkmcnt(10)
    v_mfma_f32_16x16x32_bf16 v[224:227], v[192:195], v[132:135], v[224:227]
    ds_read_b64 v[144:145], v121 offset:1728
    v_mfma_f32_16x16x32_bf16 v[220:223], v[188:191], v[132:135], v[220:223]
    ds_read_b64 v[146:147], v121 offset:1736
    s_waitcnt lgkmcnt(10)
    v_mfma_f32_16x16x32_bf16 v[216:219], v[184:187], v[132:135], v[216:219]
    ds_read_b64 v[148:149], v121 offset:2240
    v_mfma_f32_16x16x32_bf16 v[212:215], v[180:183], v[132:135], v[212:215]
    ds_read_b64 v[150:151], v121 offset:2248
    s_waitcnt lgkmcnt(10)
    v_mfma_f32_16x16x32_bf16 v[208:211], v[176:179], v[132:135], v[208:211]
    ds_read_b64 v[152:153], v121 offset:2752
    s_waitcnt lgkmcnt(9)
    v_mfma_f32_16x16x32_bf16 v[204:207], v[172:175], v[132:135], v[204:207]
    ds_read_b64 v[154:155], v121 offset:2760
    s_waitcnt lgkmcnt(8)
    v_mfma_f32_16x16x32_bf16 v[200:203], v[168:171], v[132:135], v[200:203]
    ds_read_b64 v[156:157], v121 offset:3264
    s_waitcnt lgkmcnt(7)
    v_mfma_f32_16x16x32_bf16 v[196:199], v[164:167], v[132:135], v[196:199]
    ds_read_b64 v[158:159], v121 offset:3272
    v_mfma_f32_16x16x32_bf16 v[224:227], v[188:191], v[136:139], v[224:227]
    ds_read_b64 v[160:161], v121 offset:3776
    v_mfma_f32_16x16x32_bf16 v[220:223], v[184:187], v[136:139], v[220:223]
    ds_read_b64 v[162:163], v121 offset:3784
    v_mfma_f32_16x16x32_bf16 v[216:219], v[180:183], v[136:139], v[216:219]
    v_mfma_f32_16x16x32_bf16 v[212:215], v[176:179], v[136:139], v[212:215]
    v_mfma_f32_16x16x32_bf16 v[208:211], v[172:175], v[136:139], v[208:211]
    v_mfma_f32_16x16x32_bf16 v[204:207], v[168:171], v[136:139], v[204:207]
    v_mfma_f32_16x16x32_bf16 v[200:203], v[164:167], v[136:139], v[200:203]
    v_mfma_f32_16x16x32_bf16 v[224:227], v[184:187], v[140:143], v[224:227]
    v_mfma_f32_16x16x32_bf16 v[220:223], v[180:183], v[140:143], v[220:223]
    v_mfma_f32_16x16x32_bf16 v[216:219], v[176:179], v[140:143], v[216:219]
    v_mfma_f32_16x16x32_bf16 v[212:215], v[172:175], v[140:143], v[212:215]
    v_mfma_f32_16x16x32_bf16 v[208:211], v[168:171], v[140:143], v[208:211]
    v_mfma_f32_16x16x32_bf16 v[204:207], v[164:167], v[140:143], v[204:207]
    s_waitcnt lgkmcnt(8)
    v_mfma_f32_16x16x32_bf16 v[224:227], v[180:183], v[144:147], v[224:227]
    v_mfma_f32_16x16x32_bf16 v[220:223], v[176:179], v[144:147], v[220:223]
    v_mfma_f32_16x16x32_bf16 v[216:219], v[172:175], v[144:147], v[216:219]
    v_mfma_f32_16x16x32_bf16 v[212:215], v[168:171], v[144:147], v[212:215]
    v_mfma_f32_16x16x32_bf16 v[208:211], v[164:167], v[144:147], v[208:211]
    s_waitcnt lgkmcnt(6)
    v_mfma_f32_16x16x32_bf16 v[224:227], v[176:179], v[148:151], v[224:227]
    v_mfma_f32_16x16x32_bf16 v[220:223], v[172:175], v[148:151], v[220:223]
    v_mfma_f32_16x16x32_bf16 v[216:219], v[168:171], v[148:151], v[216:219]
    v_mfma_f32_16x16x32_bf16 v[212:215], v[164:167], v[148:151], v[212:215]
    s_waitcnt lgkmcnt(4)
    v_mfma_f32_16x16x32_bf16 v[224:227], v[172:175], v[152:155], v[224:227]
    v_mfma_f32_16x16x32_bf16 v[220:223], v[168:171], v[152:155], v[220:223]
    v_mfma_f32_16x16x32_bf16 v[216:219], v[164:167], v[152:155], v[216:219]
    s_waitcnt lgkmcnt(2)
    v_mfma_f32_16x16x32_bf16 v[224:227], v[168:171], v[156:159], v[224:227]
    v_mfma_f32_16x16x32_bf16 v[220:223], v[164:167], v[156:159], v[220:223]
    s_waitcnt lgkmcnt(0)
    v_mfma_f32_16x16x32_bf16 v[224:227], v[164:167], v[160:163], v[224:227]
    s_cmp_eq_u32 s16, 0
    s_cbranch_scc1 MC_P0
    ds_write_b128 v124, v[196:199] offset:0
    ds_write_b128 v124, v[200:203] offset:1024
    ds_write_b128 v124, v[204:207] offset:2048
    ds_write_b128 v124, v[208:211] offset:3072
    s_branch MC_J
MC_P0:
    ds_write_b128 v124, v[212:215] offset:0
    ds_write_b128 v124, v[216:219] offset:1024
    s_nop 1
    ds_write_b128 v124, v[220:223] offset:2048
    s_nop 0
    ds_write_b128 v124, v[224:227] offset:3072
MC_J:
    s_waitcnt lgkmcnt(0)
    ds_write_b32 v127, v129 offset:8
    s_mov_b32 s10, 1
    s_cmp_lt_u32 s15, 4
    s_cbranch_scc1 M_AL
    s_branch MT_NOY
MT_ALW:
    s_waitcnt vmcnt(0)
    s_setprio 1
    v_mov_b32 v251, s56
    ds_write_b32 v239, v251
    s_mov_b64 exec, 7
    s_mov_b32 s58, 0
AW35:
    ds_read_b32 v248, v117 offset:0
    s_add_u32 s58, s58, 1
    s_waitcnt lgkmcnt(0)
    v_cmp_ne_u32 vcc, s56, v248
    s_nop 4
    s_cbranch_vccz AD36
    s_cmp_lt_u32 s58, 3200000
    s_cbranch_scc1 AW35
AD36:
    s_mov_b64 exec, -1
    s_branch MT_GO
MT_NOY:
    s_mov_b64 exec, 14
    ds_read_b32 v248, v117
    s_waitcnt lgkmcnt(0)
    v_cmp_ne_u32 vcc, s56, v248
    s_mov_b64 exec, -1
    s_nop 3
    s_cbranch_vccz MT_GO1
    s_cmp_eq_u32 s29, 0
    s_cbranch_scc1 CFE37
    s_mov_b32 s29, 0
    v_lshlrev_b32 v118, 4, v1
    s_mov_b32 s58, 0
LW40:
    ds_read_b32 v132, v128 offset:8
    s_add_u32 s58, s58, 1
    s_waitcnt lgkmcnt(0)
    v_readfirstlane_b32 s59, v132
    s_nop 0
    s_cmp_eq_u32 s59, s56
    s_cbranch_scc1 LD41
    s_cmp_lt_u32 s58, 3200000
    s_cbranch_scc1 LW40
LD41:
    ds_read_b128 v[132:135], v126 offset:0
    ds_read_b128 v[136:139], v126 offset:1024
    ds_read_b128 v[140:143], v126 offset:2048
    ds_read_b128 v[144:147], v126 offset:3072
    s_cmp_eq_u32 s16, 0
    s_waitcnt lgkmcnt(0)
    s_cbranch_scc1 CFP38
    v_add_f32 v132, v212, v132
    v_add_f32 v133, v213, v133
    v_add_f32 v134, v214, v134
    v_add_f32 v135, v215, v135
    v_add_f32 v136, v216, v136
    v_add_f32 v137, v217, v137
    v_add_f32 v138, v218, v138
    v_add_f32 v139, v219, v139
    v_add_f32 v140, v220, v140
    v_add_f32 v141, v221, v141
    v_add_f32 v142, v222, v142
    v_add_f32 v143, v223, v143
    v_add_f32 v144, v224, v144
    v_add_f32 v145, v225, v145
    v_add_f32 v146, v226, v146
    v_add_f32 v147, v227, v147
    s_branch CFJ39
CFP38:
    v_add_f32 v132, v196, v132
    v_add_f32 v133, v197, v133
    v_add_f32 v134, v198, v134
    v_add_f32 v135, v199, v135
    v_add_f32 v136, v200, v136
    v_add_f32 v137, v201, v137
    v_add_f32 v138, v202, v138
    v_add_f32 v139, v203, v139
    v_add_f32 v140, v204, v140
    v_add_f32 v141, v205, v141
    v_add_f32 v142, v206, v142
    v_add_f32 v143, v207, v143
    v_add_f32 v144, v208, v144
    v_add_f32 v145, v209, v145
    v_add_f32 v146, v210, v146
    v_add_f32 v147, v211, v147
CFJ39:
    v_cvt_pk_bf16_f32 v164, v132, v133
    ds_write_b32 v125, v164 offset:0
    v_cvt_pk_bf16_f32 v165, v134, v135
    ds_write_b32 v125, v165 offset:64
    v_cvt_pk_bf16_f32 v166, v136, v137
    ds_write_b32 v125, v166 offset:512
    v_cvt_pk_bf16_f32 v167, v138, v139
    ds_write_b32 v125, v167 offset:576
    v_cvt_pk_bf16_f32 v168, v140, v141
    ds_write_b32 v125, v168 offset:1024
    v_cvt_pk_bf16_f32 v169, v142, v143
    ds_write_b32 v125, v169 offset:1088
    v_cvt_pk_bf16_f32 v170, v144, v145
    ds_write_b32 v125, v170 offset:1536
    v_cvt_pk_bf16_f32 v171, v146, v147
    ds_write_b32 v125, v171 offset:1600
    ds_read_b128 v[132:135], v126 offset:0
    ds_read_b128 v[136:139], v126 offset:1024
    v_mov_b32 v251, s56
    s_waitcnt lgkmcnt(0)
    buffer_store_dwordx4 v[132:135], v118, s[40:43], s27 offen offset:0 sc1
    buffer_store_dwordx4 v[136:139], v118, s[40:43], s27 offen offset:1024 sc1
    s_waitcnt lgkmcnt(0)
CFE37:
    s_mov_b64 exec, 14
    s_mov_b32 s58, 0
AW42:
    ds_read_b32 v248, v117 offset:0
    s_add_u32 s58, s58, 1
    s_waitcnt lgkmcnt(0)
    v_cmp_ne_u32 vcc, s56, v248
    s_nop 4
    s_cbranch_vccz AD43
    s_cmp_lt_u32 s58, 3200000
    s_cbranch_scc1 AW42
AD43:
    s_mov_b64 exec, -1
    ds_write_b32 v239, v251
MT_GO1:
    s_setprio 2
MT_GO:
    ds_read_b128 v[12:15], v2 offset:38912
    s_mov_b32 exec_hi, 0
    ds_read_b32 v16, v3 offset:47104
    s_mov_b32 exec_hi, -1
MT_REDO:
    s_cmp_lt_u32 s5, 8
    s_cselect_b64 vcc, -1, 0
    ds_read_b128 v[20:23], v2 offset:8192
    ds_read_b32 v24, v3 offset:36864
    ds_read_b128 v[28:31], v2 offset:0
    ds_read_b32 v32, v3 offset:34816
    s_mov_b64 exec, s[8:9]
    ds_read_b128 v[36:39], v4 offset:9216
    ds_read_b128 v[40:43], v4 offset:9792
    s_mov_b64 exec, -1
    s_mov_b64 exec, s[8:9]
    ds_read_b128 v[44:47], v4 offset:0
    ds_read_b128 v[48:51], v4 offset:576
    s_mov_b64 exec, -1
    s_waitcnt lgkmcnt(6)
    v_mfma_f32_32x32x16_bf16 v[52:67], v[20:23], v[12:15], 0
    s_waitcnt lgkmcnt(4)
    v_mfma_f32_32x32x16_bf16 v[68:83], v[28:31], v[12:15], 0
    v_lshlrev_b32 v251, 7, v1
    s_and_b32 s58, s2, 0xf8
    s_add_u32 s58, s58, s15
    s_mul_i32 s58, s58, 2688
    s_mov_b64 exec, 0x1fffff
    buffer_load_dword v252, v251, s[44:47], s58 offen
    s_mov_b64 exec, -1
    s_cmp_lg_u32 s100, 0
    s_cbranch_scc1 MT_HAVEM
    s_nop 0
    v_max_f32 v10, v52, v53
    v_max_f32 v11, v54, v55
    v_max3_f32 v10, v56, v57, v10
    v_max3_f32 v11, v58, v59, v11
    v_max3_f32 v10, v60, v61, v10
    v_max3_f32 v11, v62, v63, v11
    v_max3_f32 v10, v64, v65, v10
    v_max3_f32 v11, v66, v67, v11
    v_max_f32 v10, v10, v11
    v_mov_b32 v11, v10
    s_nop 1
    v_permlane32_swap_b32 v10, v11
    v_min_f32 v10, -v10, -v11
    v_lshrrev_b32 v17, 16, v10
MT_HAVEM:
    s_nop 1
    v_mfma_f32_32x32x16_bf16 v[52:67], v[24:27], v[16:19], v[52:67]
    ds_read_b128 v[20:23], v2 offset:7168
    ds_read_b32 v24, v3 offset:36608
    v_mfma_f32_32x32x16_bf16 v[68:83], v[32:35], v[16:19], v[68:83]
    ds_read_b128 v[28:31], v2 offset:6144
    ds_read_b32 v32, v3 offset:36352
    s_cbranch_vccnz OL44
OR45:
    s_nop 8
    v_cndmask_b32 v52, v68, v52, s[64:65]
    v_cndmask_b32 v53, v69, v53, s[66:67]
    v_cndmask_b32 v54, v70, v54, s[68:69]
    v_cndmask_b32 v55, v71, v55, s[70:71]
    v_cndmask_b32 v56, v72, v56, s[72:73]
    v_cndmask_b32 v57, v73, v57, s[74:75]
    v_cndmask_b32 v58, v74, v58, s[76:77]
    v_cndmask_b32 v59, v75, v59, s[78:79]
    v_cndmask_b32 v60, v76, v60, s[80:81]
    v_cndmask_b32 v61, v77, v61, s[82:83]
    s_waitcnt lgkmcnt(2)
    v_mfma_f32_32x32x16_bf16 v[84:99], v[20:23], v[12:15], 0
    v_cndmask_b32 v62, v78, v62, s[84:85]
    v_cndmask_b32 v63, v79, v63, s[86:87]
    v_cndmask_b32 v64, v80, v64, s[88:89]
    v_cndmask_b32 v65, v81, v65, s[90:91]
    v_cndmask_b32 v66, v82, v66, s[92:93]
    v_cndmask_b32 v67, v83, v67, s[94:95]
    v_exp_f32 v52, v52
    v_exp_f32 v53, v53
    v_exp_f32 v54, v54
    v_mfma_f32_32x32x16_bf16 v[84:99], v[24:27], v[16:19], v[84:99]
    ds_read_b128 v[20:23], v2 offset:5120
    ds_read_b32 v24, v3 offset:36096
    v_exp_f32 v55, v55
    v_exp_f32 v56, v56
    v_exp_f32 v57, v57
    v_exp_f32 v58, v58
    v_exp_f32 v59, v59
    v_exp_f32 v60, v60
    v_exp_f32 v61, v61
    v_exp_f32 v62, v62
    v_exp_f32 v63, v63
    v_exp_f32 v64, v64
    v_exp_f32 v65, v65
    v_exp_f32 v66, v66
    v_exp_f32 v67, v67
    v_cvt_pk_bf16_f32 v52, v52, v53
    v_cvt_pk_bf16_f32 v53, v54, v55
    v_cvt_pk_bf16_f32 v54, v56, v57
    v_cvt_pk_bf16_f32 v55, v58, v59
    v_cvt_pk_bf16_f32 v56, v60, v61
    v_cvt_pk_bf16_f32 v57, v62, v63
    v_cvt_pk_bf16_f32 v58, v64, v65
    v_cvt_pk_bf16_f32 v59, v66, v67
    v_and_b32 v60, v52, v228
    v_and_b32 v61, v53, v229
    v_and_b32 v62, v54, v230
    v_and_b32 v63, v55, v231
    v_and_b32 v64, v56, v232
    v_and_b32 v65, v57, v233
    v_and_b32 v66, v58, v234
    v_mfma_f32_32x32x16_bf16 v[100:115], v[36:39], v[60:63], 0
    v_and_b32 v67, v59, v235
    v_xor_b32 v52, v52, v60
    v_xor_b32 v53, v53, v61
    v_xor_b32 v54, v54, v62
    v_xor_b32 v55, v55, v63
    v_xor_b32 v56, v56, v64
    v_xor_b32 v57, v57, v65
    v_xor_b32 v58, v58, v66
    v_mfma_f32_32x32x16_bf16 v[100:115], v[40:43], v[64:67], v[100:115]
    s_mov_b64 exec, s[8:9]
    ds_read_b128 v[36:39], v4 offset:8064
    ds_read_b128 v[40:43], v4 offset:8640
    s_mov_b64 exec, -1
    v_xor_b32 v59, v59, v67
    s_cmp_lg_u32 s29, 0
    s_cbranch_scc1 OL46
OR47:
    s_cmp_eq_u32 s60, 13
    s_cbranch_scc1 OL48
OR49:
    s_cbranch_vccnz OL50
OR51:
    s_waitcnt lgkmcnt(4)
    v_mfma_f32_32x32x16_bf16 v[68:83], v[28:31], v[12:15], 0
    v_exp_f32 v84, v84
    v_exp_f32 v85, v85
    v_exp_f32 v86, v86
    v_exp_f32 v87, v87
    v_mfma_f32_32x32x16_bf16 v[68:83], v[32:35], v[16:19], v[68:83]
    ds_read_b128 v[28:31], v2 offset:4096
    ds_read_b32 v32, v3 offset:35840
    v_exp_f32 v88, v88
    v_exp_f32 v89, v89
    v_exp_f32 v90, v90
    v_exp_f32 v91, v91
    v_cvt_pk_bf16_f32 v84, v84, v85
    s_cbranch_vccnz MT_NOOLD1
    v_mfma_f32_32x32x16_bf16 v[100:115], v[44:47], v[52:55], v[100:115]
MT_NOOLD1:
    v_cvt_pk_bf16_f32 v85, v86, v87
    v_exp_f32 v92, v92
    v_exp_f32 v93, v93
    v_exp_f32 v94, v94
    v_exp_f32 v95, v95
    s_cbranch_vccnz MT_NOOLD2
    v_mfma_f32_32x32x16_bf16 v[100:115], v[48:51], v[56:59], v[100:115]
MT_NOOLD2:
    s_mov_b64 exec, s[8:9]
    ds_read_b128 v[44:47], v4 offset:6912
    ds_read_b128 v[48:51], v4 offset:7488
    s_mov_b64 exec, -1
    v_exp_f32 v96, v96
    v_exp_f32 v97, v97
    v_exp_f32 v98, v98
    v_exp_f32 v99, v99
    v_cvt_pk_bf16_f32 v86, v88, v89
    v_cvt_pk_bf16_f32 v87, v90, v91
    v_cvt_pk_bf16_f32 v88, v92, v93
    v_cvt_pk_bf16_f32 v89, v94, v95
    v_cvt_pk_bf16_f32 v90, v96, v97
    v_cvt_pk_bf16_f32 v91, v98, v99
    s_cbranch_vccnz OL52
OR53:
    s_waitcnt lgkmcnt(6)
    v_mfma_f32_32x32x16_bf16 v[52:67], v[20:23], v[12:15], 0
    v_exp_f32 v68, v68
    v_exp_f32 v69, v69
    v_exp_f32 v70, v70
    v_exp_f32 v71, v71
    v_mfma_f32_32x32x16_bf16 v[52:67], v[24:27], v[16:19], v[52:67]
    ds_read_b128 v[20:23], v2 offset:3072
    ds_read_b32 v24, v3 offset:35584
    v_exp_f32 v72, v72
    v_exp_f32 v73, v73
    v_exp_f32 v74, v74
    v_exp_f32 v75, v75
    v_cvt_pk_bf16_f32 v68, v68, v69
    s_waitcnt lgkmcnt(6)
    v_mfma_f32_32x32x16_bf16 v[100:115], v[36:39], v[84:87], v[100:115]
    v_cvt_pk_bf16_f32 v69, v70, v71
    v_exp_f32 v76, v76
    v_exp_f32 v77, v77
    v_exp_f32 v78, v78
    v_exp_f32 v79, v79
    v_mfma_f32_32x32x16_bf16 v[100:115], v[40:43], v[88:91], v[100:115]
    s_mov_b64 exec, s[8:9]
    ds_read_b128 v[36:39], v4 offset:5760
    ds_read_b128 v[40:43], v4 offset:6336
    s_mov_b64 exec, -1
    v_exp_f32 v80, v80
    v_exp_f32 v81, v81
    v_exp_f32 v82, v82
    v_exp_f32 v83, v83
    v_cvt_pk_bf16_f32 v70, v72, v73
    v_cvt_pk_bf16_f32 v71, v74, v75
    v_cvt_pk_bf16_f32 v72, v76, v77
    v_cvt_pk_bf16_f32 v73, v78, v79
    v_cvt_pk_bf16_f32 v74, v80, v81
    v_cvt_pk_bf16_f32 v75, v82, v83
    s_cmp_eq_u32 s101, 0
    s_cbranch_scc1 YF54
    s_waitcnt vmcnt(0)
    v_mov_b32 v248, s56
    v_mov_b32 v249, s57
    v_mov_b32 v250, 0
    s_mov_b64 exec, 1
    buffer_store_dwordx2 v[248:249], v250, s[40:43], s101 offen sc1
    s_mov_b64 exec, -1
    s_mov_b32 s101, 0
YF54:
    s_cmp_ge_u32 s60, 8
    s_cbranch_scc1 MT_NOGATE
    s_mov_b64 exec, 255
    s_mov_b32 s58, 0
AW55:
    ds_read_b32 v248, v117 offset:0
    s_add_u32 s58, s58, 1
    s_waitcnt lgkmcnt(0)
    v_cmp_ne_u32 vcc, s56, v248
    s_nop 4
    s_cbranch_vccz AD56
    s_cmp_lt_u32 s58, 3200000
    s_cbranch_scc1 AW55
AD56:
    s_mov_b64 exec, -1
MT_NOGATE:
    s_mov_b64 exec, 1
    buffer_load_dword v252, v19, s[40:43], s7 offen
    s_mov_b64 exec, -1
    s_cmp_ge_u32 s60, 8
    s_cbranch_scc1 WS57
    s_bfe_u32 s58, s2, 0x20003
    s_lshl1_add_u32 s58, s58, s60
    s_and_b32 s58, s58, 7
    s_mul_i32 s59, s58, 12288
    s_add_u32 m0, s59, s61
    s_mul_i32 s59, s58, 82944
    s_add_u32 s59, s59, s62
    buffer_load_dwordx4 v240, s[44:47], s59 offen offset:0 lds
    buffer_load_dwordx4 v241, s[44:47], s59 offen offset:1024 lds
    buffer_load_dwordx4 v242, s[44:47], s59 offen offset:2048 lds
    s_add_u32 s60, s60, 2
WS57:
    s_cbranch_vccnz OL58
OR59:
    s_waitcnt lgkmcnt(6)
    v_mfma_f32_32x32x16_bf16 v[84:99], v[28:31], v[12:15], 0
    v_exp_f32 v52, v52
    v_exp_f32 v53, v53
    v_exp_f32 v54, v54
    v_exp_f32 v55, v55
    v_mfma_f32_32x32x16_bf16 v[84:99], v[32:35], v[16:19], v[84:99]
    ds_read_b128 v[28:31], v2 offset:2048
    ds_read_b32 v32, v3 offset:35328
    v_exp_f32 v56, v56
    v_exp_f32 v57, v57
    v_exp_f32 v58, v58
    v_exp_f32 v59, v59
    v_cvt_pk_bf16_f32 v52, v52, v53
    s_waitcnt lgkmcnt(6)
    v_mfma_f32_32x32x16_bf16 v[100:115], v[44:47], v[68:71], v[100:115]
    v_cvt_pk_bf16_f32 v53, v54, v55
    v_exp_f32 v60, v60
    v_exp_f32 v61, v61
    v_exp_f32 v62, v62
    v_exp_f32 v63, v63
    v_mfma_f32_32x32x16_bf16 v[100:115], v[48:51], v[72:75], v[100:115]
    s_mov_b64 exec, s[8:9]
    ds_read_b128 v[44:47], v4 offset:4608
    ds_read_b128 v[48:51], v4 offset:5184
    s_mov_b64 exec, -1
    v_exp_f32 v64, v64
    v_exp_f32 v65, v65
    v_exp_f32 v66, v66
    v_exp_f32 v67, v67
    v_cvt_pk_bf16_f32 v54, v56, v57
    v_cvt_pk_bf16_f32 v55, v58, v59
    v_cvt_pk_bf16_f32 v56, v60, v61
    v_cvt_pk_bf16_f32 v57, v62, v63
    v_cvt_pk_bf16_f32 v58, v64, v65
    v_cvt_pk_bf16_f32 v59, v66, v67
    s_cmp_ge_u32 s60, 8
    s_cbranch_scc1 WS60
    s_bfe_u32 s58, s2, 0x20003
    s_lshl1_add_u32 s58, s58, s60
    s_and_b32 s58, s58, 7
    s_mul_i32 s59, s58, 12288
    s_add_u32 m0, s59, s61
    s_mul_i32 s59, s58, 82944
    s_add_u32 s59, s59, s62
    buffer_load_dwordx4 v240, s[44:47], s59 offen offset:0 lds
    buffer_load_dwordx4 v241, s[44:47], s59 offen offset:1024 lds
    buffer_load_dwordx4 v242, s[44:47], s59 offen offset:2048 lds
    s_add_u32 s60, s60, 2
WS60:
    s_cbranch_vccnz OL61
OR62:
    s_waitcnt lgkmcnt(6)
    v_mfma_f32_32x32x16_bf16 v[68:83], v[20:23], v[12:15], 0
    v_exp_f32 v84, v84
    v_exp_f32 v85, v85
    v_exp_f32 v86, v86
    v_exp_f32 v87, v87
    v_mfma_f32_32x32x16_bf16 v[68:83], v[24:27], v[16:19], v[68:83]
    ds_read_b128 v[20:23], v2 offset:1024
    ds_read_b32 v24, v3 offset:35072
    v_exp_f32 v88, v88
    v_exp_f32 v89, v89
    v_exp_f32 v90, v90
    v_exp_f32 v91, v91
    v_cvt_pk_bf16_f32 v84, v84, v85
    s_waitcnt lgkmcnt(6)
    v_mfma_f32_32x32x16_bf16 v[100:115], v[36:39], v[52:55], v[100:115]
    v_cvt_pk_bf16_f32 v85, v86, v87
    v_exp_f32 v92, v92
    v_exp_f32 v93, v93
    v_exp_f32 v94, v94
    v_exp_f32 v95, v95
    v_mfma_f32_32x32x16_bf16 v[100:115], v[40:43], v[56:59], v[100:115]
    s_mov_b64 exec, s[8:9]
    ds_read_b128 v[36:39], v4 offset:3456
    ds_read_b128 v[40:43], v4 offset:4032
    s_mov_b64 exec, -1
    v_exp_f32 v96, v96
    v_exp_f32 v97, v97
    v_exp_f32 v98, v98
    v_exp_f32 v99, v99
    v_cvt_pk_bf16_f32 v86, v88, v89
    v_cvt_pk_bf16_f32 v87, v90, v91
    v_cvt_pk_bf16_f32 v88, v92, v93
    v_cvt_pk_bf16_f32 v89, v94, v95
    v_cvt_pk_bf16_f32 v90, v96, v97
    v_cvt_pk_bf16_f32 v91, v98, v99
    s_cmp_ge_u32 s60, 8
    s_cbranch_scc1 WS63
    s_bfe_u32 s58, s2, 0x20003
    s_lshl1_add_u32 s58, s58, s60
    s_and_b32 s58, s58, 7
    s_mul_i32 s59, s58, 12288
    s_add_u32 m0, s59, s61
    s_mul_i32 s59, s58, 82944
    s_add_u32 s59, s59, s62
    buffer_load_dwordx4 v240, s[44:47], s59 offen offset:0 lds
    buffer_load_dwordx4 v241, s[44:47], s59 offen offset:1024 lds
    buffer_load_dwordx4 v242, s[44:47], s59 offen offset:2048 lds
    s_add_u32 s60, s60, 2
WS63:
    s_cbranch_vccnz OL64
OR65:
    s_waitcnt lgkmcnt(6)
    v_mfma_f32_32x32x16_bf16 v[52:67], v[28:31], v[12:15], 0
    v_exp_f32 v68, v68
    v_exp_f32 v69, v69
    v_exp_f32 v70, v70
    v_exp_f32 v71, v71
    v_mfma_f32_32x32x16_bf16 v[52:67], v[32:35], v[16:19], v[52:67]
    v_exp_f32 v72, v72
    v_exp_f32 v73, v73
    v_exp_f32 v74, v74
    v_exp_f32 v75, v75
    v_cvt_pk_bf16_f32 v68, v68, v69
    s_waitcnt lgkmcnt(4)
    v_mfma_f32_32x32x16_bf16 v[100:115], v[44:47], v[84:87], v[100:115]
    v_cvt_pk_bf16_f32 v69, v70, v71
    v_exp_f32 v76, v76
    v_exp_f32 v77, v77
    v_exp_f32 v78, v78
    v_exp_f32 v79, v79
    v_mfma_f32_32x32x16_bf16 v[100:115], v[48:51], v[88:91], v[100:115]
    s_mov_b64 exec, s[8:9]
    ds_read_b128 v[44:47], v4 offset:2304
    ds_read_b128 v[48:51], v4 offset:2880
    s_mov_b64 exec, -1
    v_exp_f32 v80, v80
    v_exp_f32 v81, v81
    v_exp_f32 v82, v82
    v_exp_f32 v83, v83
    v_cvt_pk_bf16_f32 v70, v72, v73
    v_cvt_pk_bf16_f32 v71, v74, v75
    v_cvt_pk_bf16_f32 v72, v76, v77
    v_cvt_pk_bf16_f32 v73, v78, v79
    v_cvt_pk_bf16_f32 v74, v80, v81
    v_cvt_pk_bf16_f32 v75, v82, v83
    s_setprio 0
    s_cmp_ge_u32 s60, 8
    s_cbranch_scc1 WS66
    s_bfe_u32 s58, s2, 0x20003
    s_lshl1_add_u32 s58, s58, s60
    s_and_b32 s58, s58, 7
    s_mul_i32 s59, s58, 12288
    s_add_u32 m0, s59, s61
    s_mul_i32 s59, s58, 82944
    s_add_u32 s59, s59, s62
    buffer_load_dwordx4 v240, s[44:47], s59 offen offset:0 lds
    buffer_load_dwordx4 v241, s[44:47], s59 offen offset:1024 lds
    buffer_load_dwordx4 v242, s[44:47], s59 offen offset:2048 lds
    s_add_u32 s60, s60, 2
WS66:
    s_cbranch_vccnz OL67
OR68:
    s_waitcnt lgkmcnt(4)
    v_mfma_f32_32x32x16_bf16 v[84:99], v[20:23], v[12:15], 0
    v_exp_f32 v52, v52
    v_exp_f32 v53, v53
    v_exp_f32 v54, v54
    v_exp_f32 v55, v55
    v_mfma_f32_32x32x16_bf16 v[84:99], v[24:27], v[16:19], v[84:99]
    v_exp_f32 v56, v56
    v_exp_f32 v57, v57
    v_exp_f32 v58, v58
    v_exp_f32 v59, v59
    v_cvt_pk_bf16_f32 v52, v52, v53
    s_waitcnt lgkmcnt(2)
    v_mfma_f32_32x32x16_bf16 v[100:115], v[36:39], v[68:71], v[100:115]
    v_cvt_pk_bf16_f32 v53, v54, v55
    v_exp_f32 v60, v60
    v_exp_f32 v61, v61
    v_exp_f32 v62, v62
    v_exp_f32 v63, v63
    v_mfma_f32_32x32x16_bf16 v[100:115], v[40:43], v[72:75], v[100:115]
    s_mov_b64 exec, s[8:9]
    ds_read_b128 v[36:39], v4 offset:1152
    ds_read_b128 v[40:43], v4 offset:1728
    s_mov_b64 exec, -1
    v_exp_f32 v64, v64
    v_exp_f32 v65, v65
    v_exp_f32 v66, v66
    v_exp_f32 v67, v67
    v_cvt_pk_bf16_f32 v54, v56, v57
    v_cvt_pk_bf16_f32 v55, v58, v59
    v_cvt_pk_bf16_f32 v56, v60, v61
    v_cvt_pk_bf16_f32 v57, v62, v63
    v_cvt_pk_bf16_f32 v58, v64, v65
    v_cvt_pk_bf16_f32 v59, v66, v67
    s_cmp_lg_u32 s60, 8
    s_cbranch_scc1 WT69
    s_mul_i32 s59, 8, 12288
    s_add_u32 m0, s59, s61
    s_mov_b32 s59, s1
    buffer_load_dwordx4 v243, s[44:47], s59 offen offset:0 lds
    buffer_load_dwordx4 v244, s[44:47], s59 offen offset:1024 lds
    buffer_load_dwordx4 v245, s[44:47], s59 offen offset:2048 lds
    s_mov_b32 s60, 9
WT69:
    s_cbranch_vccnz OL70
OR71:
    v_exp_f32 v84, v84
    v_exp_f32 v85, v85
    v_exp_f32 v86, v86
    v_exp_f32 v87, v87
    v_exp_f32 v88, v88
    v_exp_f32 v89, v89
    v_exp_f32 v90, v90
    v_exp_f32 v91, v91
    v_cvt_pk_bf16_f32 v84, v84, v85
    s_waitcnt lgkmcnt(2)
    v_mfma_f32_32x32x16_bf16 v[100:115], v[44:47], v[52:55], v[100:115]
    v_cvt_pk_bf16_f32 v85, v86, v87
    v_exp_f32 v92, v92
    v_exp_f32 v93, v93
    v_exp_f32 v94, v94
    v_exp_f32 v95, v95
    v_mfma_f32_32x32x16_bf16 v[100:115], v[48:51], v[56:59], v[100:115]
    v_exp_f32 v96, v96
    v_exp_f32 v97, v97
    v_exp_f32 v98, v98
    v_exp_f32 v99, v99
    v_cvt_pk_bf16_f32 v86, v88, v89
    v_cvt_pk_bf16_f32 v87, v90, v91
    v_cvt_pk_bf16_f32 v88, v92, v93
    v_cvt_pk_bf16_f32 v89, v94, v95
    v_cvt_pk_bf16_f32 v90, v96, v97
    v_cvt_pk_bf16_f32 v91, v98, v99
    s_waitcnt lgkmcnt(0)
    v_mfma_f32_32x32x16_bf16 v[100:115], v[36:39], v[84:87], v[100:115]
    v_mfma_f32_32x32x16_bf16 v[100:115], v[40:43], v[88:91], v[100:115]
MT_P2X:
    s_nop 11
    v_max3_f32 v10, |v100|, |v101|, |v102|
    v_max3_f32 v11, |v103|, |v104|, |v105|
    v_max3_f32 v10, |v106|, |v107|, v10
    v_max3_f32 v11, |v108|, |v109|, v11
    v_mul_f32 v248, 0x5d800000, v110
    v_max3_f32 v10, v10, v11, v248
    v_rcp_f32 v11, v110
    v_cmp_nlt_f32 vcc, v10, v116
    v_cmp_nlt_f32 s[98:99], s6, v110
    v_mul_f32 v100, v100, v11
    v_mul_f32 v101, v101, v11
    v_mul_f32 v102, v102, v11
    v_mul_f32 v103, v103, v11
    v_mul_f32 v104, v104, v11
    v_mul_f32 v105, v105, v11
    v_mul_f32 v106, v106, v11
    v_mul_f32 v107, v107, v11
    v_mul_f32 v108, v108, v11
    v_mul_f32 v109, v109, v11
    s_or_b64 vcc, vcc, s[98:99]
    s_cbranch_scc1 MT_BAD
MT_STORE:
    v_cvt_pk_bf16_f32 v136, v108, v109
    v_cvt_pk_bf16_f32 v128, v100, v101
    v_cvt_pk_bf16_f32 v129, v102, v103
    v_cvt_pk_bf16_f32 v130, v104, v105
    v_cvt_pk_bf16_f32 v131, v106, v107
    buffer_store_dwordx4 v[128:131], v5, s[40:43], s12 offen sc1
    v_mov_b32_dpp v132, v136 quad_perm:[0,0,0,0] row_mask:0xf bank_mask:0xf
    v_mov_b32_dpp v133, v136 quad_perm:[1,1,1,1] row_mask:0xf bank_mask:0xf
    v_mov_b32_dpp v134, v136 quad_perm:[2,2,2,2] row_mask:0xf bank_mask:0xf
    v_mov_b32_dpp v135, v136 quad_perm:[3,3,3,3] row_mask:0xf bank_mask:0xf
    s_mov_b32 exec_lo, 0x11111111
    s_mov_b32 exec_hi, 0
    buffer_store_dwordx4 v[132:135], v6, s[40:43], s13 offen sc1
    s_mov_b64 exec, -1
    s_branch M_POST
MT_X7:
    s_waitcnt lgkmcnt(0)
    v_mfma_f32_32x32x16_bf16 v[100:115], v[36:39], v[84:87], v[100:115]
    v_mfma_f32_32x32x16_bf16 v[100:115], v[40:43], v[88:91], v[100:115]
    s_branch MT_P2X
MT_X6:
    s_waitcnt lgkmcnt(0)
    v_mfma_f32_32x32x16_bf16 v[100:115], v[44:47], v[68:71], v[100:115]
    v_mfma_f32_32x32x16_bf16 v[100:115], v[48:51], v[72:75], v[100:115]
    s_branch MT_P2X
MT_X5:
    s_waitcnt lgkmcnt(0)
    v_mfma_f32_32x32x16_bf16 v[100:115], v[36:39], v[52:55], v[100:115]
    v_mfma_f32_32x32x16_bf16 v[100:115], v[40:43], v[56:59], v[100:115]
    s_branch MT_P2X
MT_X4:
    s_waitcnt lgkmcnt(0)
    v_mfma_f32_32x32x16_bf16 v[100:115], v[44:47], v[84:87], v[100:115]
    v_mfma_f32_32x32x16_bf16 v[100:115], v[48:51], v[88:91], v[100:115]
    s_branch MT_P2X
MT_X3:
    s_waitcnt lgkmcnt(0)
    v_mfma_f32_32x32x16_bf16 v[100:115], v[36:39], v[68:71], v[100:115]
    v_mfma_f32_32x32x16_bf16 v[100:115], v[40:43], v[72:75], v[100:115]
    s_branch MT_P2X
MT_X2:
    s_waitcnt lgkmcnt(0)
    v_mfma_f32_32x32x16_bf16 v[100:115], v[44:47], v[52:55], v[100:115]
    v_mfma_f32_32x32x16_bf16 v[100:115], v[48:51], v[56:59], v[100:115]
    s_branch MT_P2X
MT_BAD:
    s_cmp_lg_u32 s100, 0
    s_cbranch_scc1 MT_STORE
    s_mov_b32 s100, 1
    s_waitcnt lgkmcnt(0)
    v_mov_b32 v133, 0
    v_mov_b32 v134, 0
    v_mov_b32 v135, 0
    v_add_u32 v7, 0, v2
    v_add_u32 v9, 34816, v3
    ds_read_b128 v[128:131], v7 offset:8192
    ds_read_b32 v132, v9 offset:2048
    s_waitcnt lgkmcnt(0)
    v_mfma_f32_32x32x16_bf16 v[52:67], v[128:131], v[12:15], 0
    v_mfma_f32_32x32x16_bf16 v[52:67], v[132:135], v[16:19], v[52:67]
    s_nop 15
    ds_read_b128 v[128:131], v7 offset:0
    ds_read_b32 v132, v9 offset:0
    s_waitcnt lgkmcnt(0)
    v_mfma_f32_32x32x16_bf16 v[68:83], v[128:131], v[12:15], 0
    v_mfma_f32_32x32x16_bf16 v[68:83], v[132:135], v[16:19], v[68:83]
    s_nop 15
    s_cmp_ge_u32 s5, 8
    s_cbranch_scc1 MT_XOLD
    v_mov_b32 v68, 0xf149f2ca
    v_mov_b32 v69, 0xf149f2ca
    v_mov_b32 v70, 0xf149f2ca
    v_mov_b32 v71, 0xf149f2ca
    v_mov_b32 v72, 0xf149f2ca
    v_mov_b32 v73, 0xf149f2ca
    v_mov_b32 v74, 0xf149f2ca
    v_mov_b32 v75, 0xf149f2ca
    v_mov_b32 v76, 0xf149f2ca
    v_mov_b32 v77, 0xf149f2ca
    v_mov_b32 v78, 0xf149f2ca
    v_mov_b32 v79, 0xf149f2ca
    v_mov_b32 v80, 0xf149f2ca
    v_mov_b32 v81, 0xf149f2ca
    v_mov_b32 v82, 0xf149f2ca
    v_mov_b32 v83, 0xf149f2ca
MT_XOLD:
    v_cndmask_b32 v52, v68, v52, s[64:65]
    v_cndmask_b32 v53, v69, v53, s[66:67]
    v_cndmask_b32 v54, v70, v54, s[68:69]
    v_cndmask_b32 v55, v71, v55, s[70:71]
    v_cndmask_b32 v56, v72, v56, s[72:73]
    v_cndmask_b32 v57, v73, v57, s[74:75]
    v_cndmask_b32 v58, v74, v58, s[76:77]
    v_cndmask_b32 v59, v75, v59, s[78:79]
    v_cndmask_b32 v60, v76, v60, s[80:81]
    v_cndmask_b32 v61, v77, v61, s[82:83]
    v_cndmask_b32 v62, v78, v62, s[84:85]
    v_cndmask_b32 v63, v79, v63, s[86:87]
    v_cndmask_b32 v64, v80, v64, s[88:89]
    v_cndmask_b32 v65, v81, v65, s[90:91]
    v_cndmask_b32 v66, v82, v66, s[92:93]
    v_cndmask_b32 v67, v83, v67, s[94:95]
    v_max_f32 v10, v52, v53
    v_max_f32 v11, v54, v55
    v_max3_f32 v10, v56, v57, v10
    v_max3_f32 v11, v58, v59, v11
    v_max3_f32 v10, v60, v61, v10
    v_max3_f32 v11, v62, v63, v11
    v_max3_f32 v10, v64, v65, v10
    v_max3_f32 v11, v66, v67, v11
    s_min_u32 s58, s5, 7
MT_EXLOOP:
    s_cmp_eq_u32 s58, 0
    s_cbranch_scc1 MT_EXEND
    ds_read_b128 v[128:131], v7 offset:7168
    ds_read_b32 v132, v9 offset:1792
    s_waitcnt lgkmcnt(0)
    v_mfma_f32_32x32x16_bf16 v[68:83], v[128:131], v[12:15], 0
    v_mfma_f32_32x32x16_bf16 v[68:83], v[132:135], v[16:19], v[68:83]
    s_nop 15
    v_subrev_u32 v7, 1024, v7
    v_subrev_u32 v9, 256, v9
    s_sub_u32 s58, s58, 1
    v_max3_f32 v10, v68, v69, v10
    v_max3_f32 v11, v70, v71, v11
    v_max3_f32 v10, v72, v73, v10
    v_max3_f32 v11, v74, v75, v11
    v_max3_f32 v10, v76, v77, v10
    v_max3_f32 v11, v78, v79, v11
    v_max3_f32 v10, v80, v81, v10
    v_max3_f32 v11, v82, v83, v11
    s_branch MT_EXLOOP
MT_EXEND:
    v_max_f32 v10, v10, v11
    v_mov_b32 v11, v10
    s_nop 1
    v_permlane32_swap_b32 v10, v11
    v_min_f32 v11, -v10, -v11
    s_mov_b32 s58, 0x07060302
    v_and_b32 v248, 0xffff0000, v11
    v_sub_f32 v249, v11, v248
    v_perm_b32 v17, v249, v248, s58
    v_and_b32 v248, 0xffff0000, v249
    v_sub_f32 v249, v249, v248
    v_lshrrev_b32 v18, 16, v249
    s_branch MT_REDO
OL44:
    s_nop 8
    v_mov_b32 v68, 0xf149f2ca
    v_mov_b32 v69, 0xf149f2ca
    v_mov_b32 v70, 0xf149f2ca
    v_mov_b32 v71, 0xf149f2ca
    v_mov_b32 v72, 0xf149f2ca
    v_mov_b32 v73, 0xf149f2ca
    v_mov_b32 v74, 0xf149f2ca
    v_mov_b32 v75, 0xf149f2ca
    v_mov_b32 v76, 0xf149f2ca
    v_mov_b32 v77, 0xf149f2ca
    v_mov_b32 v78, 0xf149f2ca
    v_mov_b32 v79, 0xf149f2ca
    v_mov_b32 v80, 0xf149f2ca
    v_mov_b32 v81, 0xf149f2ca
    v_mov_b32 v82, 0xf149f2ca
    v_mov_b32 v83, 0xf149f2ca
    s_branch OR45
OL46:
    s_cmp_eq_u32 s29, 0
    s_cbranch_scc1 CFE72
    s_mov_b32 s29, 0
    v_lshlrev_b32 v118, 4, v1
    s_mov_b32 s58, 0
LW75:
    ds_read_b32 v132, v128 offset:8
    s_add_u32 s58, s58, 1
    s_waitcnt lgkmcnt(0)
    v_readfirstlane_b32 s59, v132
    s_nop 0
    s_cmp_eq_u32 s59, s56
    s_cbranch_scc1 LD76
    s_cmp_lt_u32 s58, 3200000
    s_cbranch_scc1 LW75
LD76:
    ds_read_b128 v[132:135], v126 offset:0
    ds_read_b128 v[136:139], v126 offset:1024
    ds_read_b128 v[140:143], v126 offset:2048
    ds_read_b128 v[144:147], v126 offset:3072
    s_cmp_eq_u32 s16, 0
    s_waitcnt lgkmcnt(0)
    s_cbranch_scc1 CFP73
    v_add_f32 v132, v212, v132
    v_add_f32 v133, v213, v133
    v_add_f32 v134, v214, v134
    v_add_f32 v135, v215, v135
    v_add_f32 v136, v216, v136
    v_add_f32 v137, v217, v137
    v_add_f32 v138, v218, v138
    v_add_f32 v139, v219, v139
    v_add_f32 v140, v220, v140
    v_add_f32 v141, v221, v141
    v_add_f32 v142, v222, v142
    v_add_f32 v143, v223, v143
    v_add_f32 v144, v224, v144
    v_add_f32 v145, v225, v145
    v_add_f32 v146, v226, v146
    v_add_f32 v147, v227, v147
    s_branch CFJ74
CFP73:
    v_add_f32 v132, v196, v132
    v_add_f32 v133, v197, v133
    v_add_f32 v134, v198, v134
    v_add_f32 v135, v199, v135
    v_add_f32 v136, v200, v136
    v_add_f32 v137, v201, v137
    v_add_f32 v138, v202, v138
    v_add_f32 v139, v203, v139
    v_add_f32 v140, v204, v140
    v_add_f32 v141, v205, v141
    v_add_f32 v142, v206, v142
    v_add_f32 v143, v207, v143
    v_add_f32 v144, v208, v144
    v_add_f32 v145, v209, v145
    v_add_f32 v146, v210, v146
    v_add_f32 v147, v211, v147
CFJ74:
    v_cvt_pk_bf16_f32 v164, v132, v133
    ds_write_b32 v125, v164 offset:0
    v_cvt_pk_bf16_f32 v165, v134, v135
    ds_write_b32 v125, v165 offset:64
    v_cvt_pk_bf16_f32 v166, v136, v137
    ds_write_b32 v125, v166 offset:512
    v_cvt_pk_bf16_f32 v167, v138, v139
    ds_write_b32 v125, v167 offset:576
    v_cvt_pk_bf16_f32 v168, v140, v141
    ds_write_b32 v125, v168 offset:1024
    v_cvt_pk_bf16_f32 v169, v142, v143
    ds_write_b32 v125, v169 offset:1088
    v_cvt_pk_bf16_f32 v170, v144, v145
    ds_write_b32 v125, v170 offset:1536
    v_cvt_pk_bf16_f32 v171, v146, v147
    ds_write_b32 v125, v171 offset:1600
    ds_read_b128 v[132:135], v126 offset:0
    ds_read_b128 v[136:139], v126 offset:1024
    v_mov_b32 v251, s56
    s_waitcnt lgkmcnt(0)
    ds_write_b32 v239, v251
    buffer_store_dwordx4 v[132:135], v118, s[40:43], s27 offen offset:0 sc1
    buffer_store_dwordx4 v[136:139], v118, s[40:43], s27 offen offset:1024 sc1
    s_waitcnt lgkmcnt(0)
CFE72:
    s_branch OR47
OL48:
    s_cmp_lg_u32 s60, 13
    s_cbranch_scc1 QP77
    s_mov_b32 s60, 11
    s_sub_u32 s16, s2, 192
    s_lshl_b32 s17, s15, 6
    s_add_u32 s17, s17, s16
    s_and_b32 s18, s16, 7
    s_lshr_b32 s19, s17, 3
    s_cmp_ge_u32 s17, 256
    s_cselect_b32 s18, 8, s18
    s_cselect_b32 s19, s16, s19
    s_cmp_ge_u32 s17, 288
    s_cbranch_scc1 QP77
    v_lshrrev_b32 v140, 3, v1
    s_lshl_b32 s58, s19, 3
    v_add_u32 v140, s58, v140
    v_mul_u32_u24 v140, 9216, v140
    v_and_b32 v141, 7, v1
    s_lshl_b32 s58, s18, 7
    v_lshl_add_u32 v141, v141, 4, s58
    v_add_u32 v140, v140, v141
    v_add_u32 v141, 4608, v140
    s_mov_b32 s48, s22
    s_mov_b32 s49, s23
    s_mov_b32 s50, 2359296
    s_mov_b32 s51, 0x00020000
    buffer_load_dwordx4 v[144:147], v140, s[48:51], 0 offen offset:0 nt
    buffer_load_dwordx4 v[148:151], v140, s[48:51], 0 offen offset:1152 nt
    buffer_load_dwordx4 v[152:155], v140, s[48:51], 0 offen offset:2304 nt
    buffer_load_dwordx4 v[156:159], v140, s[48:51], 0 offen offset:3456 nt
    buffer_load_dwordx4 v[160:163], v141, s[48:51], 0 offen offset:0 nt
    buffer_load_dwordx4 v[164:167], v141, s[48:51], 0 offen offset:1152 nt
    buffer_load_dwordx4 v[168:171], v141, s[48:51], 0 offen offset:2304 nt
    buffer_load_dwordx4 v[172:175], v141, s[48:51], 0 offen offset:3456 nt
QP77:
    s_branch OR49
OL50:
    s_cmp_le_u32 s5, 0
    s_cbranch_scc1 MT_P2X
    s_branch OR51
OL52:
    s_cmp_le_u32 s5, 1
    s_cbranch_scc1 MT_X7
    s_branch OR53
OL58:
    s_cmp_le_u32 s5, 2
    s_cbranch_scc1 MT_X6
    s_branch OR59
OL61:
    s_cmp_le_u32 s5, 3
    s_cbranch_scc1 MT_X5
    s_branch OR62
OL64:
    s_cmp_le_u32 s5, 4
    s_cbranch_scc1 MT_X4
    s_branch OR65
OL67:
    s_cmp_le_u32 s5, 5
    s_cbranch_scc1 MT_X3
    s_branch OR68
OL70:
    s_cmp_le_u32 s5, 6
    s_cbranch_scc1 MT_X2
    s_branch OR71
M_POST:
    s_mov_b32 s63, s7
    s_setprio 0
    s_cmp_ge_u32 s2, 192
    s_cbranch_scc1 M_STAGE3
    s_and_b32 s4, s2, 7
    s_bfe_u32 s5, s2, 0x20003
    s_lshl_b32 s6, s4, 2
    s_add_u32 s6, s6, s5
    s_lshl_b32 s6, s6, 2
    s_add_u32 s6, s6, s3
    s_lshr_b32 s7, s15, 2
    v_and_b32 v14, 15, v1
    v_lshrrev_b32 v15, 4, v1
    v_lshlrev_b32 v2, 4, v1
    v_lshlrev_b32 v3, 15, v15
    v_lshl_add_u32 v3, v14, 2, v3
    s_lshl_b32 s8, s6, 14
    s_mul_i32 s9, s7, 9216
    s_add_u32 s8, s8, s9
    s_add_u32 s8, s8, 7340032
    s_lshl_b32 s9, s6, 6
    s_add_u32 s9, s9, 9437184
    v_lshrrev_b32 v4, 1, v15
    v_lshlrev_b32 v4, 4, v4
    v_and_b32 v5, 1, v15
    v_lshl_add_u32 v4, v5, 2, v4
    v_lshrrev_b32 v6, 2, v14
    v_add_u32 v4, v4, v6
    v_mul_u32_u24 v4, 192, v4
    v_and_b32 v6, 3, v14
    v_lshl_add_u32 v4, v6, 3, v4
    v_lshl_add_u32 v4, v5, 5, v4
    v_xor_b32 v5, 32, v4
    s_mul_i32 s10, s7, 55296
    s_add_u32 s10, s10, 0
    v_add_u32 v4, s10, v4
    v_add_u32 v5, s10, v5
    s_lshl_b32 s10, s4, 12
    s_add_u32 s10, s10, 17170432
    v_lshl_add_u32 v6, v1, 7, s10
    v_and_b32 v8, 3, v14
    v_and_b32 v9, 4, v14
    v_lshl_or_b32 v8, v9, 1, v8
    v_and_b32 v9, 8, v14
    v_lshrrev_b32 v9, 1, v9
    v_or_b32 v8, v8, v9
    v_mul_u32_u24 v8, 208, v8
    v_lshl_add_u32 v8, v15, 3, v8
    s_mul_i32 s10, s3, 3328
    s_add_u32 s10, s10, 139264
    v_add_u32 v8, s10, v8
    v_add_u32 v9, 0, v1
    v_mul_u32_u24 v10, 171, v9
    v_lshrrev_b32 v10, 11, v10
    v_mul_u32_u24 v11, 12, v10
    v_sub_u32 v11, v9, v11
    v_lshlrev_b32 v11, 4, v11
    v_mul_u32_u24 v12, 208, v10
    v_add3_u32 v20, v12, v11, s10
    v_mul_u32_u24 v12, 2304, v10
    v_add_u32 v23, v12, v11
    v_add_u32 v9, 64, v1
    v_mul_u32_u24 v10, 171, v9
    v_lshrrev_b32 v10, 11, v10
    v_mul_u32_u24 v11, 12, v10
    v_sub_u32 v11, v9, v11
    v_lshlrev_b32 v11, 4, v11
    v_mul_u32_u24 v12, 208, v10
    v_add3_u32 v21, v12, v11, s10
    v_mul_u32_u24 v12, 2304, v10
    v_add_u32 v24, v12, v11
    v_add_u32 v9, 128, v1
    v_mul_u32_u24 v10, 171, v9
    v_lshrrev_b32 v10, 11, v10
    v_mul_u32_u24 v11, 12, v10
    v_sub_u32 v11, v9, v11
    v_lshlrev_b32 v11, 4, v11
    v_mul_u32_u24 v12, 208, v10
    v_add3_u32 v22, v12, v11, s10
    v_mul_u32_u24 v12, 2304, v10
    v_add_u32 v25, v12, v11
    s_mul_i32 s11, s6, 36864
    s_lshr_b32 s10, s2, 5
    s_mul_i32 s10, s10, 192
    s_add_u32 s11, s11, s10
    s_mul_i32 s10, s3, 6144
    s_add_u32 s10, s10, 114688
    v_add_u32 v7, s10, v2
    s_mov_b32 s44, s34
    s_mov_b32 s45, s35
    s_mov_b32 s46, 4718592
    s_mov_b32 s47, 0x00020000
    s_waitcnt vmcnt(0) lgkmcnt(0)
    s_barrier
    s_cmp_lg_u32 s15, 5
    s_cbranch_scc1 OF78
    v_mov_b32 v248, s56
    v_mov_b32 v249, s57
    v_mov_b32 v250, 0
    s_mov_b64 exec, 1
    buffer_store_dwordx2 v[248:249], v250, s[40:43], s63 offen sc1
    s_mov_b64 exec, -1
OF78:
    s_cmp_eq_u32 s101, 0
    s_cbranch_scc1 YF79
    v_mov_b32 v248, s56
    v_mov_b32 v249, s57
    v_mov_b32 v250, 0
    s_mov_b64 exec, 1
    buffer_store_dwordx2 v[248:249], v250, s[40:43], s101 offen sc1
    s_mov_b64 exec, -1
    s_mov_b32 s101, 0
YF79:
    s_cmp_lg_u32 s15, 0
    s_cbranch_scc1 MG_PRE
    s_mov_b32 exec_lo, -1
    s_mov_b32 exec_hi, 0
    s_mov_b32 s58, 0
PL80:
    buffer_load_dwordx2 v[16:17], v6, s[40:43], 0 offen sc1
    s_add_u32 s58, s58, 1
    s_waitcnt vmcnt(0)
    v_cmp_ne_u64 vcc, s[56:57], v[16:17]
    s_nop 4
    s_cbranch_vccz PD81
    s_cmp_lt_u32 s58, 200000
    s_cbranch_scc1 PL80
PD81:
    s_mov_b64 exec, -1
    s_branch MG_W
MG_PRE:
    ds_read_b64_tr_b16 v[92:93], v4 offset:0
    ds_read_b64_tr_b16 v[94:95], v4 offset:1536
    ds_read_b64_tr_b16 v[96:97], v5 offset:0
    ds_read_b64_tr_b16 v[98:99], v5 offset:1536
    ds_read_b64_tr_b16 v[100:101], v4 offset:64
    ds_read_b64_tr_b16 v[102:103], v4 offset:1600
    ds_read_b64_tr_b16 v[104:105], v5 offset:64
    ds_read_b64_tr_b16 v[106:107], v5 offset:1600
    ds_read_b64_tr_b16 v[108:109], v4 offset:128
    ds_read_b64_tr_b16 v[110:111], v4 offset:1664
    ds_read_b64_tr_b16 v[112:113], v5 offset:128
    ds_read_b64_tr_b16 v[114:115], v5 offset:1664
    s_waitcnt lgkmcnt(3)
    ds_read_b64_tr_b16 v[116:117], v4 offset:6144
    ds_read_b64_tr_b16 v[118:119], v4 offset:7680
    ds_read_b64_tr_b16 v[120:121], v5 offset:6144
    ds_read_b64_tr_b16 v[122:123], v5 offset:7680
    ds_read_b64_tr_b16 v[124:125], v4 offset:6208
    ds_read_b64_tr_b16 v[126:127], v4 offset:7744
    ds_read_b64_tr_b16 v[128:129], v5 offset:6208
    ds_read_b64_tr_b16 v[130:131], v5 offset:7744
    ds_read_b64_tr_b16 v[132:133], v4 offset:6272
    ds_read_b64_tr_b16 v[134:135], v4 offset:7808
    ds_read_b64_tr_b16 v[136:137], v5 offset:6272
    ds_read_b64_tr_b16 v[138:139], v5 offset:7808
    s_waitcnt lgkmcnt(3)
    ds_read_b64_tr_b16 v[140:141], v4 offset:12288
    ds_read_b64_tr_b16 v[142:143], v4 offset:13824
    ds_read_b64_tr_b16 v[144:145], v5 offset:12288
    ds_read_b64_tr_b16 v[146:147], v5 offset:13824
    ds_read_b64_tr_b16 v[148:149], v4 offset:12352
    ds_read_b64_tr_b16 v[150:151], v4 offset:13888
    ds_read_b64_tr_b16 v[152:153], v5 offset:12352
    ds_read_b64_tr_b16 v[154:155], v5 offset:13888
    ds_read_b64_tr_b16 v[156:157], v4 offset:12416
    ds_read_b64_tr_b16 v[158:159], v4 offset:13952
    ds_read_b64_tr_b16 v[160:161], v5 offset:12416
    ds_read_b64_tr_b16 v[162:163], v5 offset:13952
    s_waitcnt lgkmcnt(3)
    ds_read_b64_tr_b16 v[164:165], v4 offset:18432
    ds_read_b64_tr_b16 v[166:167], v4 offset:19968
    ds_read_b64_tr_b16 v[168:169], v5 offset:18432
    ds_read_b64_tr_b16 v[170:171], v5 offset:19968
    ds_read_b64_tr_b16 v[172:173], v4 offset:18496
    ds_read_b64_tr_b16 v[174:175], v4 offset:20032
    ds_read_b64_tr_b16 v[176:177], v5 offset:18496
    ds_read_b64_tr_b16 v[178:179], v5 offset:20032
    ds_read_b64_tr_b16 v[180:181], v4 offset:18560
    ds_read_b64_tr_b16 v[182:183], v4 offset:20096
    ds_read_b64_tr_b16 v[184:185], v5 offset:18560
    ds_read_b64_tr_b16 v[186:187], v5 offset:20096
    s_waitcnt lgkmcnt(3)
    ds_read_b64_tr_b16 v[188:189], v4 offset:24576
    ds_read_b64_tr_b16 v[190:191], v4 offset:26112
    ds_read_b64_tr_b16 v[192:193], v5 offset:24576
    ds_read_b64_tr_b16 v[194:195], v5 offset:26112
    ds_read_b64_tr_b16 v[196:197], v4 offset:24640
    ds_read_b64_tr_b16 v[198:199], v4 offset:26176
    ds_read_b64_tr_b16 v[200:201], v5 offset:24640
    ds_read_b64_tr_b16 v[202:203], v5 offset:26176
    ds_read_b64_tr_b16 v[204:205], v4 offset:24704
    ds_read_b64_tr_b16 v[206:207], v4 offset:26240
    ds_read_b64_tr_b16 v[208:209], v5 offset:24704
    ds_read_b64_tr_b16 v[210:211], v5 offset:26240
    s_waitcnt lgkmcnt(3)
    ds_read_b64_tr_b16 v[212:213], v4 offset:30720
    ds_read_b64_tr_b16 v[214:215], v4 offset:32256
    ds_read_b64_tr_b16 v[216:217], v5 offset:30720
    ds_read_b64_tr_b16 v[218:219], v5 offset:32256
    ds_read_b64_tr_b16 v[220:221], v4 offset:30784
    ds_read_b64_tr_b16 v[222:223], v4 offset:32320
    ds_read_b64_tr_b16 v[224:225], v5 offset:30784
    ds_read_b64_tr_b16 v[226:227], v5 offset:32320
    ds_read_b64_tr_b16 v[228:229], v4 offset:30848
    ds_read_b64_tr_b16 v[230:231], v4 offset:32384
    ds_read_b64_tr_b16 v[232:233], v5 offset:30848
    ds_read_b64_tr_b16 v[234:235], v5 offset:32384
    s_waitcnt lgkmcnt(3)
    s_cmp_eq_u32 s15, 0
    s_cbranch_scc1 MG_GO
MG_W:
    s_barrier
    s_cmp_lg_u32 s7, 0
    s_cbranch_scc1 MG_TAIL
    s_add_u32 s10, s8, 7168
    buffer_load_dwordx4 v[60:63], v2, s[40:43], s10 offen sc1
    buffer_load_dwordx4 v[64:67], v2, s[40:43], s10 offen offset:1024 sc1
    s_branch MG_MAIN
MG_TAIL:
    s_add_u32 s10, s9, 0
    buffer_load_dword v60, v3, s[40:43], s10 offen sc1
    s_add_u32 s10, s9, 8192
    buffer_load_dword v61, v3, s[40:43], s10 offen sc1
    s_add_u32 s10, s9, 16384
    buffer_load_dword v62, v3, s[40:43], s10 offen sc1
    s_add_u32 s10, s9, 24576
    buffer_load_dword v63, v3, s[40:43], s10 offen sc1
    s_add_u32 s10, s9, 131072
    buffer_load_dword v64, v3, s[40:43], s10 offen sc1
    s_add_u32 s10, s9, 139264
    buffer_load_dword v65, v3, s[40:43], s10 offen sc1
    s_add_u32 s10, s9, 147456
    buffer_load_dword v66, v3, s[40:43], s10 offen sc1
    s_add_u32 s10, s9, 155648
    buffer_load_dword v67, v3, s[40:43], s10 offen sc1
MG_MAIN:
    buffer_load_dwordx4 v[32:35], v2, s[40:43], s8 offen offset:0 sc1
    buffer_load_dwordx4 v[36:39], v2, s[40:43], s8 offen offset:1024 sc1
    buffer_load_dwordx4 v[40:43], v2, s[40:43], s8 offen offset:2048 sc1
    buffer_load_dwordx4 v[44:47], v2, s[40:43], s8 offen offset:3072 sc1
    s_add_u32 s8, s8, 4096
    buffer_load_dwordx4 v[48:51], v2, s[40:43], s8 offen offset:0 sc1
    buffer_load_dwordx4 v[52:55], v2, s[40:43], s8 offen offset:1024 sc1
    buffer_load_dwordx4 v[56:59], v2, s[40:43], s8 offen offset:2048 sc1
    s_cmp_eq_u32 s15, 0
    s_cbranch_scc1 MG_PRE
MG_GO:
    s_cmp_lg_u32 s7, 0
    s_cbranch_scc1 MG_GP
    s_setprio 2
MG_GP:
    s_waitcnt lgkmcnt(0)
    s_waitcnt vmcnt(6)
    v_mfma_f32_16x16x32_bf16 v[68:71], v[92:95], v[32:35], 0
    ds_read_b64_tr_b16 v[92:93], v4 offset:36864
    ds_read_b64_tr_b16 v[94:95], v4 offset:38400
    v_mfma_f32_16x16x32_bf16 v[72:75], v[96:99], v[32:35], 0
    ds_read_b64_tr_b16 v[96:97], v5 offset:36864
    ds_read_b64_tr_b16 v[98:99], v5 offset:38400
    v_mfma_f32_16x16x32_bf16 v[76:79], v[100:103], v[32:35], 0
    ds_read_b64_tr_b16 v[100:101], v4 offset:36928
    ds_read_b64_tr_b16 v[102:103], v4 offset:38464
    v_mfma_f32_16x16x32_bf16 v[80:83], v[104:107], v[32:35], 0
    ds_read_b64_tr_b16 v[104:105], v5 offset:36928
    ds_read_b64_tr_b16 v[106:107], v5 offset:38464
    v_mfma_f32_16x16x32_bf16 v[84:87], v[108:111], v[32:35], 0
    ds_read_b64_tr_b16 v[108:109], v4 offset:36992
    ds_read_b64_tr_b16 v[110:111], v4 offset:38528
    v_mfma_f32_16x16x32_bf16 v[88:91], v[112:115], v[32:35], 0
    ds_read_b64_tr_b16 v[112:113], v5 offset:36992
    ds_read_b64_tr_b16 v[114:115], v5 offset:38528
    s_waitcnt vmcnt(5)
    v_mfma_f32_16x16x32_bf16 v[68:71], v[116:119], v[36:39], v[68:71]
    ds_read_b64_tr_b16 v[116:117], v4 offset:43008
    ds_read_b64_tr_b16 v[118:119], v4 offset:44544
    v_mfma_f32_16x16x32_bf16 v[72:75], v[120:123], v[36:39], v[72:75]
    s_waitcnt lgkmcnt(12)
    ds_read_b64_tr_b16 v[120:121], v5 offset:43008
    ds_read_b64_tr_b16 v[122:123], v5 offset:44544
    v_mfma_f32_16x16x32_bf16 v[76:79], v[124:127], v[36:39], v[76:79]
    s_waitcnt lgkmcnt(12)
    ds_read_b64_tr_b16 v[124:125], v4 offset:43072
    ds_read_b64_tr_b16 v[126:127], v4 offset:44608
    v_mfma_f32_16x16x32_bf16 v[80:83], v[128:131], v[36:39], v[80:83]
    s_waitcnt lgkmcnt(12)
    ds_read_b64_tr_b16 v[128:129], v5 offset:43072
    ds_read_b64_tr_b16 v[130:131], v5 offset:44608
    v_mfma_f32_16x16x32_bf16 v[84:87], v[132:135], v[36:39], v[84:87]
    s_waitcnt lgkmcnt(12)
    ds_read_b64_tr_b16 v[132:133], v4 offset:43136
    ds_read_b64_tr_b16 v[134:135], v4 offset:44672
    v_mfma_f32_16x16x32_bf16 v[88:91], v[136:139], v[36:39], v[88:91]
    s_waitcnt lgkmcnt(12)
    ds_read_b64_tr_b16 v[136:137], v5 offset:43136
    ds_read_b64_tr_b16 v[138:139], v5 offset:44672
    s_waitcnt vmcnt(4)
    v_mfma_f32_16x16x32_bf16 v[68:71], v[140:143], v[40:43], v[68:71]
    s_waitcnt lgkmcnt(12)
    ds_read_b64_tr_b16 v[140:141], v4 offset:49152
    ds_read_b64_tr_b16 v[142:143], v4 offset:50688
    v_mfma_f32_16x16x32_bf16 v[72:75], v[144:147], v[40:43], v[72:75]
    s_waitcnt lgkmcnt(12)
    ds_read_b64_tr_b16 v[144:145], v5 offset:49152
    ds_read_b64_tr_b16 v[146:147], v5 offset:50688
    v_mfma_f32_16x16x32_bf16 v[76:79], v[148:151], v[40:43], v[76:79]
    s_waitcnt lgkmcnt(12)
    ds_read_b64_tr_b16 v[148:149], v4 offset:49216
    ds_read_b64_tr_b16 v[150:151], v4 offset:50752
    v_mfma_f32_16x16x32_bf16 v[80:83], v[152:155], v[40:43], v[80:83]
    s_waitcnt lgkmcnt(12)
    ds_read_b64_tr_b16 v[152:153], v5 offset:49216
    ds_read_b64_tr_b16 v[154:155], v5 offset:50752
    v_mfma_f32_16x16x32_bf16 v[84:87], v[156:159], v[40:43], v[84:87]
    s_waitcnt lgkmcnt(12)
    ds_read_b64_tr_b16 v[156:157], v4 offset:49280
    ds_read_b64_tr_b16 v[158:159], v4 offset:50816
    v_mfma_f32_16x16x32_bf16 v[88:91], v[160:163], v[40:43], v[88:91]
    s_waitcnt lgkmcnt(12)
    ds_read_b64_tr_b16 v[160:161], v5 offset:49280
    ds_read_b64_tr_b16 v[162:163], v5 offset:50816
    s_waitcnt vmcnt(3)
    v_mfma_f32_16x16x32_bf16 v[68:71], v[164:167], v[44:47], v[68:71]
    v_mfma_f32_16x16x32_bf16 v[72:75], v[168:171], v[44:47], v[72:75]
    v_mfma_f32_16x16x32_bf16 v[76:79], v[172:175], v[44:47], v[76:79]
    v_mfma_f32_16x16x32_bf16 v[80:83], v[176:179], v[44:47], v[80:83]
    v_mfma_f32_16x16x32_bf16 v[84:87], v[180:183], v[44:47], v[84:87]
    v_mfma_f32_16x16x32_bf16 v[88:91], v[184:187], v[44:47], v[88:91]
    s_waitcnt vmcnt(2)
    v_mfma_f32_16x16x32_bf16 v[68:71], v[188:191], v[48:51], v[68:71]
    v_mfma_f32_16x16x32_bf16 v[72:75], v[192:195], v[48:51], v[72:75]
    v_mfma_f32_16x16x32_bf16 v[76:79], v[196:199], v[48:51], v[76:79]
    v_mfma_f32_16x16x32_bf16 v[80:83], v[200:203], v[48:51], v[80:83]
    v_mfma_f32_16x16x32_bf16 v[84:87], v[204:207], v[48:51], v[84:87]
    v_mfma_f32_16x16x32_bf16 v[88:91], v[208:211], v[48:51], v[88:91]
    s_waitcnt vmcnt(1)
    v_mfma_f32_16x16x32_bf16 v[68:71], v[212:215], v[52:55], v[68:71]
    v_mfma_f32_16x16x32_bf16 v[72:75], v[216:219], v[52:55], v[72:75]
    v_mfma_f32_16x16x32_bf16 v[76:79], v[220:223], v[52:55], v[76:79]
    v_mfma_f32_16x16x32_bf16 v[80:83], v[224:227], v[52:55], v[80:83]
    v_mfma_f32_16x16x32_bf16 v[84:87], v[228:231], v[52:55], v[84:87]
    v_mfma_f32_16x16x32_bf16 v[88:91], v[232:235], v[52:55], v[88:91]
    s_waitcnt vmcnt(0)
    s_waitcnt lgkmcnt(0)
    v_mfma_f32_16x16x32_bf16 v[68:71], v[92:95], v[56:59], v[68:71]
    v_mfma_f32_16x16x32_bf16 v[72:75], v[96:99], v[56:59], v[72:75]
    v_mfma_f32_16x16x32_bf16 v[76:79], v[100:103], v[56:59], v[76:79]
    v_mfma_f32_16x16x32_bf16 v[80:83], v[104:107], v[56:59], v[80:83]
    v_mfma_f32_16x16x32_bf16 v[84:87], v[108:111], v[56:59], v[84:87]
    v_mfma_f32_16x16x32_bf16 v[88:91], v[112:115], v[56:59], v[88:91]
    v_mfma_f32_16x16x32_bf16 v[68:71], v[116:119], v[60:63], v[68:71]
    v_mfma_f32_16x16x32_bf16 v[72:75], v[120:123], v[60:63], v[72:75]
    v_mfma_f32_16x16x32_bf16 v[76:79], v[124:127], v[60:63], v[76:79]
    v_mfma_f32_16x16x32_bf16 v[80:83], v[128:131], v[60:63], v[80:83]
    v_mfma_f32_16x16x32_bf16 v[84:87], v[132:135], v[60:63], v[84:87]
    v_mfma_f32_16x16x32_bf16 v[88:91], v[136:139], v[60:63], v[88:91]
    s_cmp_eq_u32 s7, 0
    s_cbranch_scc1 MG_NB
    s_barrier
    ds_read_b128 v[164:167], v7 offset:0
    ds_read_b128 v[168:171], v7 offset:1024
    ds_read_b128 v[172:175], v7 offset:2048
    ds_read_b128 v[176:179], v7 offset:3072
    ds_read_b128 v[180:183], v7 offset:4096
    ds_read_b128 v[184:187], v7 offset:5120
MG_NB:
    v_mfma_f32_16x16x32_bf16 v[68:71], v[140:143], v[64:67], v[68:71]
    v_mfma_f32_16x16x32_bf16 v[72:75], v[144:147], v[64:67], v[72:75]
    v_mfma_f32_16x16x32_bf16 v[76:79], v[148:151], v[64:67], v[76:79]
    v_mfma_f32_16x16x32_bf16 v[80:83], v[152:155], v[64:67], v[80:83]
    v_mfma_f32_16x16x32_bf16 v[84:87], v[156:159], v[64:67], v[84:87]
    v_mfma_f32_16x16x32_bf16 v[88:91], v[160:163], v[64:67], v[88:91]
MG_FIN:
    s_cmp_lg_u32 s7, 0
    s_cbranch_scc1 MG_K0
    s_nop 0
    ds_write_b128 v7, v[68:71] offset:0
    ds_write_b128 v7, v[72:75] offset:1024
    ds_write_b128 v7, v[76:79] offset:2048
    ds_write_b128 v7, v[80:83] offset:3072
    ds_write_b128 v7, v[84:87] offset:4096
    ds_write_b128 v7, v[88:91] offset:5120
    s_waitcnt lgkmcnt(0)
    s_barrier
    s_branch M_END
MG_K0:
    s_waitcnt lgkmcnt(0)
    v_add_f32 v68, v68, v164
    v_add_f32 v69, v69, v165
    v_add_f32 v70, v70, v166
    v_add_f32 v71, v71, v167
    v_cvt_pk_bf16_f32 v32, v68, v69
    v_cvt_pk_bf16_f32 v33, v70, v71
    ds_write_b64 v8, v[32:33] offset:0
    v_add_f32 v72, v72, v168
    v_add_f32 v73, v73, v169
    v_add_f32 v74, v74, v170
    v_add_f32 v75, v75, v171
    v_cvt_pk_bf16_f32 v34, v72, v73
    v_cvt_pk_bf16_f32 v35, v74, v75
    ds_write_b64 v8, v[34:35] offset:32
    v_add_f32 v76, v76, v172
    v_add_f32 v77, v77, v173
    v_add_f32 v78, v78, v174
    v_add_f32 v79, v79, v175
    v_cvt_pk_bf16_f32 v36, v76, v77
    v_cvt_pk_bf16_f32 v37, v78, v79
    ds_write_b64 v8, v[36:37] offset:64
    v_add_f32 v80, v80, v176
    v_add_f32 v81, v81, v177
    v_add_f32 v82, v82, v178
    v_add_f32 v83, v83, v179
    v_cvt_pk_bf16_f32 v38, v80, v81
    v_cvt_pk_bf16_f32 v39, v82, v83
    ds_write_b64 v8, v[38:39] offset:96
    v_add_f32 v84, v84, v180
    v_add_f32 v85, v85, v181
    v_add_f32 v86, v86, v182
    v_add_f32 v87, v87, v183
    v_cvt_pk_bf16_f32 v40, v84, v85
    v_cvt_pk_bf16_f32 v41, v86, v87
    ds_write_b64 v8, v[40:41] offset:128
    v_add_f32 v88, v88, v184
    v_add_f32 v89, v89, v185
    v_add_f32 v90, v90, v186
    v_add_f32 v91, v91, v187
    v_cvt_pk_bf16_f32 v42, v88, v89
    v_cvt_pk_bf16_f32 v43, v90, v91
    ds_write_b64 v8, v[42:43] offset:160
    ds_read_b128 v[48:51], v20
    ds_read_b128 v[52:55], v21
    ds_read_b128 v[56:59], v22
    s_waitcnt lgkmcnt(2)
    buffer_store_dwordx4 v[48:51], v23, s[44:47], s11 offen sc0 sc1 nt
    s_waitcnt lgkmcnt(1)
    buffer_store_dwordx4 v[52:55], v24, s[44:47], s11 offen sc0 sc1 nt
    s_waitcnt lgkmcnt(0)
    buffer_store_dwordx4 v[56:59], v25, s[44:47], s11 offen sc0 sc1 nt
    s_branch M_END
M_STAGE3:
    s_sub_u32 s4, s2, 192
    s_lshl_b32 s5, s15, 6
    s_add_u32 s5, s5, s4
    s_and_b32 s6, s4, 7
    s_lshr_b32 s7, s5, 3
    s_cmp_ge_u32 s5, 256
    s_cselect_b32 s6, 8, s6
    s_cselect_b32 s7, s4, s7
    v_and_b32 v10, 7, v1
    v_lshrrev_b32 v11, 3, v1
    v_xor_b32 v12, v10, v11
    v_lshlrev_b32 v2, 15, v11
    v_lshl_add_u32 v2, v12, 4, v2
    s_lshl_b32 s8, s6, 18
    s_lshl_b32 s9, s7, 7
    s_add_u32 s8, s8, s9
    s_add_u32 s8, s8, 13631488
    s_lshl_b32 s9, s15, 13
    v_lshl_add_u32 v3, v10, 3, v12
    v_lshl_add_u32 v3, v3, 4, s9
    s_lshl_b32 s10, s7, 3
    v_add_u32 v4, s10, v11
    v_mul_u32_u24 v4, 9216, v4
    s_lshl_b32 s10, s6, 7
    v_lshl_add_u32 v5, v10, 4, s10
    v_lshl_add_u32 v6, v4, 1, v5
    v_add_u32 v4, v4, v5
    v_add_u32 v5, 4608, v4
    s_lshl_b32 s10, s6, 14
    s_lshr_b32 s11, s7, 4
    s_lshl_b32 s11, s11, 7
    s_add_u32 s10, s10, s11
    s_add_u32 s10, s10, 16908288
    v_lshl_add_u32 v8, v1, 8, s10
    s_mov_b32 s44, s34
    s_mov_b32 s45, s35
    s_mov_b32 s46, 4718592
    s_mov_b32 s47, 0x00020000
    s_waitcnt vmcnt(0)
    s_barrier
    s_cmp_lg_u32 s15, 5
    s_cbranch_scc1 OF82
    v_mov_b32 v248, s56
    v_mov_b32 v249, s57
    v_mov_b32 v250, 0
    s_mov_b64 exec, 1
    buffer_store_dwordx2 v[248:249], v250, s[40:43], s63 offen sc1
    s_mov_b64 exec, -1
OF82:
    s_cmp_eq_u32 s101, 0
    s_cbranch_scc1 YF83
    v_mov_b32 v248, s56
    v_mov_b32 v249, s57
    v_mov_b32 v250, 0
    s_mov_b64 exec, 1
    buffer_store_dwordx2 v[248:249], v250, s[40:43], s101 offen sc1
    s_mov_b64 exec, -1
    s_mov_b32 s101, 0
YF83:
    s_cmp_ge_u32 s5, 288
    s_cbranch_scc1 M_END
    s_mov_b32 exec_lo, -1
    s_mov_b32 exec_hi, -1
    s_mov_b32 s58, 0
PL84:
    buffer_load_dwordx2 v[14:15], v8, s[40:43], 0 offen sc1
    s_add_u32 s58, s58, 1
    s_waitcnt vmcnt(0)
    v_cmp_ne_u64 vcc, s[56:57], v[14:15]
    s_nop 4
    s_cbranch_vccz PD85
    s_cmp_lt_u32 s58, 200000
    s_cbranch_scc1 PL84
PD85:
    s_mov_b64 exec, -1
    s_add_u32 m0, s9, 0
    s_add_u32 s10, s8, 0
    buffer_load_dwordx4 v2, s[40:43], s10 offen sc1 lds
    s_add_u32 m0, s9, 1024
    s_add_u32 s10, s8, 4096
    buffer_load_dwordx4 v2, s[40:43], s10 offen sc1 lds
    s_add_u32 m0, s9, 2048
    s_add_u32 s10, s8, 8192
    buffer_load_dwordx4 v2, s[40:43], s10 offen sc1 lds
    s_add_u32 m0, s9, 3072
    s_add_u32 s10, s8, 12288
    buffer_load_dwordx4 v2, s[40:43], s10 offen sc1 lds
    s_add_u32 m0, s9, 4096
    s_add_u32 s10, s8, 16384
    buffer_load_dwordx4 v2, s[40:43], s10 offen sc1 lds
    s_add_u32 m0, s9, 5120
    s_add_u32 s10, s8, 20480
    buffer_load_dwordx4 v2, s[40:43], s10 offen sc1 lds
    s_add_u32 m0, s9, 6144
    s_add_u32 s10, s8, 24576
    buffer_load_dwordx4 v2, s[40:43], s10 offen sc1 lds
    s_add_u32 m0, s9, 7168
    s_add_u32 s10, s8, 28672
    buffer_load_dwordx4 v2, s[40:43], s10 offen sc1 lds
    s_mov_b32 s11, 0xffff0000
    s_waitcnt vmcnt(0)
    ds_read_b128 v[16:19], v3 offset:0
    ds_read_b128 v[20:23], v3 offset:1024
    ds_read_b128 v[24:27], v3 offset:2048
    ds_read_b128 v[28:31], v3 offset:3072
    ds_read_b128 v[32:35], v3 offset:4096
    ds_read_b128 v[36:39], v3 offset:5120
    ds_read_b128 v[40:43], v3 offset:6144
    ds_read_b128 v[44:47], v3 offset:7168
    s_waitcnt lgkmcnt(7)
    v_lshlrev_b32 v48, 16, v16
    v_and_b32 v56, s11, v16
    v_lshlrev_b32 v64, 16, v17
    v_and_b32 v72, s11, v17
    v_lshlrev_b32 v80, 16, v18
    v_and_b32 v88, s11, v18
    v_lshlrev_b32 v96, 16, v19
    v_and_b32 v104, s11, v19
    s_waitcnt lgkmcnt(6)
    v_lshlrev_b32 v49, 16, v20
    v_and_b32 v57, s11, v20
    v_lshlrev_b32 v65, 16, v21
    v_and_b32 v73, s11, v21
    v_lshlrev_b32 v81, 16, v22
    v_and_b32 v89, s11, v22
    v_lshlrev_b32 v97, 16, v23
    v_and_b32 v105, s11, v23
    s_waitcnt lgkmcnt(5)
    v_lshlrev_b32 v50, 16, v24
    v_and_b32 v58, s11, v24
    v_lshlrev_b32 v66, 16, v25
    v_and_b32 v74, s11, v25
    v_lshlrev_b32 v82, 16, v26
    v_and_b32 v90, s11, v26
    v_lshlrev_b32 v98, 16, v27
    v_and_b32 v106, s11, v27
    s_waitcnt lgkmcnt(4)
    v_lshlrev_b32 v51, 16, v28
    v_and_b32 v59, s11, v28
    v_lshlrev_b32 v67, 16, v29
    v_and_b32 v75, s11, v29
    v_lshlrev_b32 v83, 16, v30
    v_and_b32 v91, s11, v30
    v_lshlrev_b32 v99, 16, v31
    v_and_b32 v107, s11, v31
    s_waitcnt lgkmcnt(3)
    v_lshlrev_b32 v52, 16, v32
    v_and_b32 v60, s11, v32
    v_lshlrev_b32 v68, 16, v33
    v_and_b32 v76, s11, v33
    v_lshlrev_b32 v84, 16, v34
    v_and_b32 v92, s11, v34
    v_lshlrev_b32 v100, 16, v35
    v_and_b32 v108, s11, v35
    s_waitcnt lgkmcnt(2)
    v_lshlrev_b32 v53, 16, v36
    v_and_b32 v61, s11, v36
    v_lshlrev_b32 v69, 16, v37
    v_and_b32 v77, s11, v37
    v_lshlrev_b32 v85, 16, v38
    v_and_b32 v93, s11, v38
    v_lshlrev_b32 v101, 16, v39
    v_and_b32 v109, s11, v39
    s_waitcnt lgkmcnt(1)
    v_lshlrev_b32 v54, 16, v40
    v_and_b32 v62, s11, v40
    v_lshlrev_b32 v70, 16, v41
    v_and_b32 v78, s11, v41
    v_lshlrev_b32 v86, 16, v42
    v_and_b32 v94, s11, v42
    v_lshlrev_b32 v102, 16, v43
    v_and_b32 v110, s11, v43
    s_waitcnt lgkmcnt(0)
    v_lshlrev_b32 v55, 16, v44
    v_and_b32 v63, s11, v44
    v_lshlrev_b32 v71, 16, v45
    v_and_b32 v79, s11, v45
    v_lshlrev_b32 v87, 16, v46
    v_and_b32 v95, s11, v46
    v_lshlrev_b32 v103, 16, v47
    v_and_b32 v111, s11, v47
    v_lshlrev_b32 v112, 16, v144
    v_and_b32 v113, s11, v144
    v_lshlrev_b32 v114, 16, v145
    v_and_b32 v115, s11, v145
    v_lshlrev_b32 v116, 16, v146
    v_and_b32 v117, s11, v146
    v_lshlrev_b32 v118, 16, v147
    v_and_b32 v119, s11, v147
    v_mul_f32 v112, v112, v48
    v_mul_f32 v113, v113, v49
    v_mul_f32 v114, v114, v50
    v_mul_f32 v115, v115, v51
    v_mul_f32 v116, v116, v52
    v_mul_f32 v117, v117, v53
    v_mul_f32 v118, v118, v54
    v_mul_f32 v119, v119, v55
    v_cvt_pk_bf16_f32 v144, v112, v113
    v_cvt_pk_bf16_f32 v145, v114, v115
    v_cvt_pk_bf16_f32 v146, v116, v117
    v_cvt_pk_bf16_f32 v147, v118, v119
    s_movk_i32 s10, 1152
    buffer_store_dwordx4 v[144:147], v6, s[44:47], s10 offen sc0 sc1 nt
    v_lshlrev_b32 v120, 16, v148
    v_and_b32 v121, s11, v148
    v_lshlrev_b32 v122, 16, v149
    v_and_b32 v123, s11, v149
    v_lshlrev_b32 v124, 16, v150
    v_and_b32 v125, s11, v150
    v_lshlrev_b32 v126, 16, v151
    v_and_b32 v127, s11, v151
    v_mul_f32 v120, v120, v56
    v_mul_f32 v121, v121, v57
    v_mul_f32 v122, v122, v58
    v_mul_f32 v123, v123, v59
    v_mul_f32 v124, v124, v60
    v_mul_f32 v125, v125, v61
    v_mul_f32 v126, v126, v62
    v_mul_f32 v127, v127, v63
    v_cvt_pk_bf16_f32 v148, v120, v121
    v_cvt_pk_bf16_f32 v149, v122, v123
    v_cvt_pk_bf16_f32 v150, v124, v125
    v_cvt_pk_bf16_f32 v151, v126, v127
    s_movk_i32 s10, 3456
    buffer_store_dwordx4 v[148:151], v6, s[44:47], s10 offen sc0 sc1 nt
    v_lshlrev_b32 v112, 16, v152
    v_and_b32 v113, s11, v152
    v_lshlrev_b32 v114, 16, v153
    v_and_b32 v115, s11, v153
    v_lshlrev_b32 v116, 16, v154
    v_and_b32 v117, s11, v154
    v_lshlrev_b32 v118, 16, v155
    v_and_b32 v119, s11, v155
    v_mul_f32 v112, v112, v64
    v_mul_f32 v113, v113, v65
    v_mul_f32 v114, v114, v66
    v_mul_f32 v115, v115, v67
    v_mul_f32 v116, v116, v68
    v_mul_f32 v117, v117, v69
    v_mul_f32 v118, v118, v70
    v_mul_f32 v119, v119, v71
    v_cvt_pk_bf16_f32 v152, v112, v113
    v_cvt_pk_bf16_f32 v153, v114, v115
    v_cvt_pk_bf16_f32 v154, v116, v117
    v_cvt_pk_bf16_f32 v155, v118, v119
    s_movk_i32 s10, 5760
    buffer_store_dwordx4 v[152:155], v6, s[44:47], s10 offen sc0 sc1 nt
    v_lshlrev_b32 v120, 16, v156
    v_and_b32 v121, s11, v156
    v_lshlrev_b32 v122, 16, v157
    v_and_b32 v123, s11, v157
    v_lshlrev_b32 v124, 16, v158
    v_and_b32 v125, s11, v158
    v_lshlrev_b32 v126, 16, v159
    v_and_b32 v127, s11, v159
    v_mul_f32 v120, v120, v72
    v_mul_f32 v121, v121, v73
    v_mul_f32 v122, v122, v74
    v_mul_f32 v123, v123, v75
    v_mul_f32 v124, v124, v76
    v_mul_f32 v125, v125, v77
    v_mul_f32 v126, v126, v78
    v_mul_f32 v127, v127, v79
    v_cvt_pk_bf16_f32 v156, v120, v121
    v_cvt_pk_bf16_f32 v157, v122, v123
    v_cvt_pk_bf16_f32 v158, v124, v125
    v_cvt_pk_bf16_f32 v159, v126, v127
    s_movk_i32 s10, 8064
    buffer_store_dwordx4 v[156:159], v6, s[44:47], s10 offen sc0 sc1 nt
    v_lshlrev_b32 v112, 16, v160
    v_and_b32 v113, s11, v160
    v_lshlrev_b32 v114, 16, v161
    v_and_b32 v115, s11, v161
    v_lshlrev_b32 v116, 16, v162
    v_and_b32 v117, s11, v162
    v_lshlrev_b32 v118, 16, v163
    v_and_b32 v119, s11, v163
    v_mul_f32 v112, v112, v80
    v_mul_f32 v113, v113, v81
    v_mul_f32 v114, v114, v82
    v_mul_f32 v115, v115, v83
    v_mul_f32 v116, v116, v84
    v_mul_f32 v117, v117, v85
    v_mul_f32 v118, v118, v86
    v_mul_f32 v119, v119, v87
    v_cvt_pk_bf16_f32 v160, v112, v113
    v_cvt_pk_bf16_f32 v161, v114, v115
    v_cvt_pk_bf16_f32 v162, v116, v117
    v_cvt_pk_bf16_f32 v163, v118, v119
    s_movk_i32 s10, 10368
    buffer_store_dwordx4 v[160:163], v6, s[44:47], s10 offen sc0 sc1 nt
    v_lshlrev_b32 v120, 16, v164
    v_and_b32 v121, s11, v164
    v_lshlrev_b32 v122, 16, v165
    v_and_b32 v123, s11, v165
    v_lshlrev_b32 v124, 16, v166
    v_and_b32 v125, s11, v166
    v_lshlrev_b32 v126, 16, v167
    v_and_b32 v127, s11, v167
    v_mul_f32 v120, v120, v88
    v_mul_f32 v121, v121, v89
    v_mul_f32 v122, v122, v90
    v_mul_f32 v123, v123, v91
    v_mul_f32 v124, v124, v92
    v_mul_f32 v125, v125, v93
    v_mul_f32 v126, v126, v94
    v_mul_f32 v127, v127, v95
    v_cvt_pk_bf16_f32 v164, v120, v121
    v_cvt_pk_bf16_f32 v165, v122, v123
    v_cvt_pk_bf16_f32 v166, v124, v125
    v_cvt_pk_bf16_f32 v167, v126, v127
    s_movk_i32 s10, 12672
    buffer_store_dwordx4 v[164:167], v6, s[44:47], s10 offen sc0 sc1 nt
    v_lshlrev_b32 v112, 16, v168
    v_and_b32 v113, s11, v168
    v_lshlrev_b32 v114, 16, v169
    v_and_b32 v115, s11, v169
    v_lshlrev_b32 v116, 16, v170
    v_and_b32 v117, s11, v170
    v_lshlrev_b32 v118, 16, v171
    v_and_b32 v119, s11, v171
    v_mul_f32 v112, v112, v96
    v_mul_f32 v113, v113, v97
    v_mul_f32 v114, v114, v98
    v_mul_f32 v115, v115, v99
    v_mul_f32 v116, v116, v100
    v_mul_f32 v117, v117, v101
    v_mul_f32 v118, v118, v102
    v_mul_f32 v119, v119, v103
    v_cvt_pk_bf16_f32 v168, v112, v113
    v_cvt_pk_bf16_f32 v169, v114, v115
    v_cvt_pk_bf16_f32 v170, v116, v117
    v_cvt_pk_bf16_f32 v171, v118, v119
    s_movk_i32 s10, 14976
    buffer_store_dwordx4 v[168:171], v6, s[44:47], s10 offen sc0 sc1 nt
    v_lshlrev_b32 v120, 16, v172
    v_and_b32 v121, s11, v172
    v_lshlrev_b32 v122, 16, v173
    v_and_b32 v123, s11, v173
    v_lshlrev_b32 v124, 16, v174
    v_and_b32 v125, s11, v174
    v_lshlrev_b32 v126, 16, v175
    v_and_b32 v127, s11, v175
    v_mul_f32 v120, v120, v104
    v_mul_f32 v121, v121, v105
    v_mul_f32 v122, v122, v106
    v_mul_f32 v123, v123, v107
    v_mul_f32 v124, v124, v108
    v_mul_f32 v125, v125, v109
    v_mul_f32 v126, v126, v110
    v_mul_f32 v127, v127, v111
    v_cvt_pk_bf16_f32 v172, v120, v121
    v_cvt_pk_bf16_f32 v173, v122, v123
    v_cvt_pk_bf16_f32 v174, v124, v125
    v_cvt_pk_bf16_f32 v175, v126, v127
    s_movk_i32 s10, 17280
    buffer_store_dwordx4 v[172:175], v6, s[44:47], s10 offen sc0 sc1 nt
M_END:
M_EXIT:
    s_endpgm
.p2align 8
.fill 1024, 4, 0xbf810000
.type M_TAB,@object
M_TAB:
.long 0xffffffff, 0xfffff0f0, 0xfffffffe, 0xfffff0e0, 0xfffffffc, 0xfffff0c0, 0xfffffff8, 0xfffff080
.long 0xfffffff0, 0xfffff000, 0xfffffef0, 0xffffe000, 0xfffffcf0, 0xffffc000, 0xfffff8f0, 0xffff8000
.long 0xffff0000, 0xf0f00000, 0xfffe0000, 0xf0e00000, 0xfffc0000, 0xf0c00000, 0xfff80000, 0xf0800000
.long 0xfff00000, 0xf0000000, 0xfef00000, 0xe0000000, 0xfcf00000, 0xc0000000, 0xf8f00000, 0x80000000
.long 0xffff, 0x0, 0x0, 0x0, 0xffffffff, 0x0, 0x0, 0x0
.long 0xffffffff, 0xffff, 0x0, 0x0, 0xffffffff, 0xffffffff, 0x0, 0x0
.long 0xffffffff, 0xffffffff, 0xffffffff, 0xffffffff, 0xffffffff, 0xffffffff, 0xffffffff, 0xffffffff
.long 0xffffffff, 0xffffffff, 0xffffffff, 0xffffffff, 0xffffffff, 0xffffffff, 0xffffffff, 0xffffffff
.long 0xffffffff, 0xffffffff, 0xffff, 0x0, 0xffffffff, 0xffffffff, 0xffffffff, 0x0
.long 0xffffffff, 0xffffffff, 0xffffffff, 0xffff, 0xffffffff, 0xffffffff, 0xffffffff, 0xffffffff
.long 0xffffffff, 0xffffffff, 0xffffffff, 0xffffffff, 0xffffffff, 0xffffffff, 0xffffffff, 0xffffffff
.long 0xffffffff, 0xffffffff, 0xffffffff, 0xffffffff, 0xffffffff, 0xffffffff, 0xffffffff, 0xffffffff
.long 0xffffffff, 0xffffffff, 0xffffffff, 0xffffffff, 0xffffffff, 0xffffffff, 0xffffffff, 0xffffffff
.long 0xffffffff, 0xffffffff, 0xffffffff, 0xffffffff, 0xffffffff, 0xffffffff, 0xffffffff, 0xffffffff
.long 0xffffffff, 0xffffffff, 0xffffffff, 0xffffffff, 0xffffffff, 0xffffffff, 0xffffffff, 0xffffffff
.long 0xffffffff, 0xffffffff, 0xffffffff, 0xffffffff, 0xffffffff, 0xffffffff, 0xffffffff, 0xffffffff
.long 0xffffffff, 0xffffffff, 0xffffffff, 0xffffffff, 0xffffffff, 0xffffffff, 0xffffffff, 0xffffffff
.long 0xffffffff, 0xffffffff, 0xffffffff, 0xffffffff, 0xffffffff, 0xffffffff, 0xffffffff, 0xffffffff
.long 0xffffffff, 0xffffffff, 0xffffffff, 0xffffffff, 0xffffffff, 0xffffffff, 0xffffffff, 0xffffffff
.long 0xffffffff, 0xffffffff, 0xffffffff, 0xffffffff, 0xffffffff, 0xffffffff, 0xffffffff, 0xffffffff
.long 0x0, 0x0, 0x0, 0x0, 0x0, 0x0, 0x0, 0x0
.long 0x0, 0x0, 0x0, 0x0, 0x0, 0x0, 0x0, 0x0
.long 0xffff, 0x0, 0x0, 0x0, 0xffffffff, 0x0, 0x0, 0x0
.long 0xffffffff, 0xffff, 0x0, 0x0, 0xffffffff, 0xffffffff, 0x0, 0x0
.long 0x0, 0x0, 0x0, 0x0, 0x0, 0x0, 0x0, 0x0
.long 0x0, 0x0, 0x0, 0x0, 0x0, 0x0, 0x0, 0x0
.long 0xffffffff, 0xffffffff, 0xffff, 0x0, 0xffffffff, 0xffffffff, 0xffffffff, 0x0
.long 0xffffffff, 0xffffffff, 0xffffffff, 0xffff, 0xffffffff, 0xffffffff, 0xffffffff, 0xffffffff
.long 0xffffffff, 0xffffffff, 0xffffffff, 0xffffffff, 0xffffffff, 0xffffffff, 0xffffffff, 0xffffffff
.long 0xffffffff, 0xffffffff, 0xffffffff, 0xffffffff, 0xffffffff, 0xffffffff, 0xffffffff, 0xffffffff
.long 0xffffffff, 0xffffffff, 0xffffffff, 0xffffffff, 0xffffffff, 0xffffffff, 0xffffffff, 0xffffffff
.long 0xffffffff, 0xffffffff, 0xffffffff, 0xffffffff, 0xffffffff, 0xffffffff, 0xffffffff, 0xffffffff
.long 0xffffffff, 0xffffffff, 0xffffffff, 0xffffffff, 0xffffffff, 0xffffffff, 0xffffffff, 0xffffffff
.long 0xffffffff, 0xffffffff, 0xffffffff, 0xffffffff, 0xffffffff, 0xffffffff, 0xffffffff, 0xffffffff
.long 0xffffffff, 0xffffffff, 0xffffffff, 0xffffffff, 0xffffffff, 0xffffffff, 0xffffffff, 0xffffffff
.long 0xffffffff, 0xffffffff, 0xffffffff, 0xffffffff, 0xffffffff, 0xffffffff, 0xffffffff, 0xffffffff
.long 0x0, 0x0, 0x0, 0x0, 0x0, 0x0, 0x0, 0x0
.long 0x0, 0x0, 0x0, 0x0, 0x0, 0x0, 0x0, 0x0
.long 0x0, 0x0, 0x0, 0x0, 0x0, 0x0, 0x0, 0x0
.long 0x0, 0x0, 0x0, 0x0, 0x0, 0x0, 0x0, 0x0
.long 0x0, 0x0, 0x0, 0x0, 0x0, 0x0, 0x0, 0x0
.long 0x0, 0x0, 0x0, 0x0, 0x0, 0x0, 0x0, 0x0
.long 0x0, 0x0, 0x0, 0x0, 0x0, 0x0, 0x0, 0x0
.long 0x0, 0x0, 0x0, 0x0, 0x0, 0x0, 0x0, 0x0
.long 0xffff, 0x0, 0x0, 0x0, 0xffffffff, 0x0, 0x0, 0x0
.long 0xffffffff, 0xffff, 0x0, 0x0, 0xffffffff, 0xffffffff, 0x0, 0x0
.long 0xffffffff, 0xffffffff, 0xffffffff, 0xffffffff, 0xffffffff, 0xffffffff, 0xffffffff, 0xffffffff
.long 0xffffffff, 0xffffffff, 0xffffffff, 0xffffffff, 0xffffffff, 0xffffffff, 0xffffffff, 0xffffffff
.long 0xffffffff, 0xffffffff, 0xffff, 0x0, 0xffffffff, 0xffffffff, 0xffffffff, 0x0
.long 0xffffffff, 0xffffffff, 0xffffffff, 0xffff, 0xffffffff, 0xffffffff, 0xffffffff, 0xffffffff
.long 0xffffffff, 0xffffffff, 0xffffffff, 0xffffffff, 0xffffffff, 0xffffffff, 0xffffffff, 0xffffffff
.long 0xffffffff, 0xffffffff, 0xffffffff, 0xffffffff, 0xffffffff, 0xffffffff, 0xffffffff, 0xffffffff
.long 0x0, 0x0, 0x0, 0x0, 0x0, 0x0, 0x0, 0x0
.long 0x0, 0x0, 0x0, 0x0, 0x0, 0x0, 0x0, 0x0
.long 0x0, 0x0, 0x0, 0x0, 0x0, 0x0, 0x0, 0x0
.long 0x0, 0x0, 0x0, 0x0, 0x0, 0x0, 0x0, 0x0
.long 0x0, 0x0, 0x0, 0x0, 0x0, 0x0, 0x0, 0x0
.long 0x0, 0x0, 0x0, 0x0, 0x0, 0x0, 0x0, 0x0
.long 0x0, 0x0, 0x0, 0x0, 0x0, 0x0, 0x0, 0x0
.long 0x0, 0x0, 0x0, 0x0, 0x0, 0x0, 0x0, 0x0
.long 0x0, 0x0, 0x0, 0x0, 0x0, 0x0, 0x0, 0x0
.long 0x0, 0x0, 0x0, 0x0, 0x0, 0x0, 0x0, 0x0
.long 0xffff, 0x0, 0x0, 0x0, 0xffffffff, 0x0, 0x0, 0x0
.long 0xffffffff, 0xffff, 0x0, 0x0, 0xffffffff, 0xffffffff, 0x0, 0x0
.long 0x0, 0x0, 0x0, 0x0, 0x0, 0x0, 0x0, 0x0
.long 0x0, 0x0, 0x0, 0x0, 0x0, 0x0, 0x0, 0x0
.long 0xffffffff, 0xffffffff, 0xffff, 0x0, 0xffffffff, 0xffffffff, 0xffffffff, 0x0
.long 0xffffffff, 0xffffffff, 0xffffffff, 0xffff, 0xffffffff, 0xffffffff, 0xffffffff, 0xffffffff
.long 0x0, 0x24e0, 0x1380, 0x4800, 0x10, 0x24f0, 0x1390, 0x4810
.long 0x20, 0x24c0, 0x13a0, 0x4820, 0x30, 0x24d0, 0x13b0, 0x4830
.long 0x40, 0x2520, 0x1780, 0x4840, 0x50, 0x2530, 0x1790, 0x4850
.long 0x60, 0x2500, 0x17a0, 0x4860, 0x70, 0x2510, 0x17b0, 0x4870
.long 0x80, 0x2920, 0x17c0, 0x4880, 0x90, 0x2930, 0x17d0, 0x4890
.long 0xa0, 0x2900, 0x17e0, 0x48a0, 0xb0, 0x2910, 0x17f0, 0x48b0
.long 0x480, 0x2960, 0x1800, 0x4c80, 0x490, 0x2970, 0x1810, 0x4c90
.long 0x4a0, 0x2940, 0x1820, 0x4ca0, 0x4b0, 0x2950, 0x1830, 0x4cb0
.long 0x4c0, 0x29a0, 0x2e20, 0x4cc0, 0x4d0, 0x29b0, 0x2e30, 0x4cd0
.long 0x4e0, 0x2980, 0x2e00, 0x4ce0, 0x4f0, 0x2990, 0x2e10, 0x4cf0
.long 0x500, 0x2da0, 0x2e60, 0x4d00, 0x510, 0x2db0, 0x2e70, 0x4d10
.long 0x520, 0x2d80, 0x2e40, 0x4d20, 0x530, 0x2d90, 0x2e50, 0x4d30
.long 0x900, 0x2de0, 0x2ea0, 0x9900, 0x910, 0x2df0, 0x2eb0, 0x9910
.long 0x920, 0x2dc0, 0x2e80, 0x9920, 0x930, 0x2dd0, 0x2e90, 0x9930
.long 0x940, 0x2e20, 0x32a0, 0x9940, 0x950, 0x2e30, 0x32b0, 0x9950
.long 0x960, 0x2e00, 0x3280, 0x9960, 0x970, 0x2e10, 0x3290, 0x9970
.long 0x980, 0xe00, 0x32e0, 0x9980, 0x990, 0xe10, 0x32f0, 0x9990
.long 0x9a0, 0xe20, 0x32c0, 0x99a0, 0x9b0, 0xe30, 0x32d0, 0x99b0
.long 0xd80, 0xe40, 0x3320, 0x9d80, 0xd90, 0xe50, 0x3330, 0x9d90
.long 0xda0, 0xe60, 0x3300, 0x9da0, 0xdb0, 0xe70, 0x3310, 0x9db0
.long 0xdc0, 0xe80, 0x3720, 0x9dc0, 0xdd0, 0xe90, 0x3730, 0x9dd0
.long 0xde0, 0xea0, 0x3700, 0x9de0, 0xdf0, 0xeb0, 0x3710, 0x9df0
.long 0xe00, 0x1280, 0x3760, 0x9e00, 0xe10, 0x1290, 0x3770, 0x9e10
.long 0xe20, 0x12a0, 0x3740, 0x9e20, 0xe30, 0x12b0, 0x3750, 0x9e30
.long 0x2420, 0x12c0, 0x37a0, 0x18c20, 0x2430, 0x12d0, 0x37b0, 0x18c30
.long 0x2400, 0x12e0, 0x3780, 0x18c00, 0x2410, 0x12f0, 0x3790, 0x18c10
.long 0x2460, 0x1300, 0x3ba0, 0x18c60, 0x2470, 0x1310, 0x3bb0, 0x18c70
.long 0x2440, 0x1320, 0x3b80, 0x18c40, 0x2450, 0x1330, 0x3b90, 0x18c50
.long 0x24a0, 0x1700, 0x3be0, 0x18ca0, 0x24b0, 0x1710, 0x3bf0, 0x18cb0
.long 0x2480, 0x1720, 0x3bc0, 0x18c80, 0x2490, 0x1730, 0x3bd0, 0x18c90
.long 0x28a0, 0x1740, 0x3c20, 0x190a0, 0x28b0, 0x1750, 0x3c30, 0x190b0
.long 0x2880, 0x1760, 0x3c00, 0x19080, 0x2890, 0x1770, 0x3c10, 0x19090
.long 0x18ce0, 0x13380, 0x0, 0x0, 0x18cf0, 0x13390, 0x10, 0x10
.long 0x18cc0, 0x133a0, 0x20, 0x20, 0x18cd0, 0x133b0, 0x30, 0x30
.long 0x18d20, 0x13780, 0x40, 0x80, 0x18d30, 0x13790, 0x50, 0x90
.long 0x18d00, 0x137a0, 0x60, 0xa0, 0x18d10, 0x137b0, 0x70, 0xb0
.long 0x1d920, 0x137c0, 0x8, 0x40, 0x1d930, 0x137d0, 0x18, 0x50
.long 0x1d900, 0x137e0, 0x28, 0x60, 0x1d910, 0x137f0, 0x38, 0x70
.long 0x1d960, 0x13800, 0x48, 0xc0, 0x1d970, 0x13810, 0x58, 0xd0
.long 0x1d940, 0x13820, 0x68, 0xe0, 0x1d950, 0x13830, 0x78, 0xf0
.long 0x1d9a0, 0x22620, 0x80, 0x100, 0x1d9b0, 0x22630, 0x90, 0x110
.long 0x1d980, 0x22600, 0xa0, 0x120, 0x1d990, 0x22610, 0xb0, 0x130
.long 0x1dda0, 0x22660, 0xc0, 0x140, 0x1ddb0, 0x22670, 0xd0, 0x150
.long 0x1dd80, 0x22640, 0xe0, 0x160, 0x1dd90, 0x22650, 0xf0, 0x170
.long 0x1dde0, 0x226a0, 0x88, 0x180, 0x1ddf0, 0x226b0, 0x98, 0x190
.long 0x1ddc0, 0x22680, 0xa8, 0x1a0, 0x1ddd0, 0x22690, 0xb8, 0x1b0
.long 0x1de20, 0x22aa0, 0xc8, 0x1c0, 0x1de30, 0x22ab0, 0xd8, 0x1d0
.long 0x1de00, 0x22a80, 0xe8, 0x1e0, 0x1de10, 0x22a90, 0xf8, 0x1f0
.long 0xe600, 0x22ae0, 0x0, 0x120, 0xe610, 0x22af0, 0x10, 0x130
.long 0xe620, 0x22ac0, 0x20, 0x140, 0xe630, 0x22ad0, 0x30, 0x150
.long 0xe640, 0x22b20, 0x40, 0x1a0, 0xe650, 0x22b30, 0x50, 0x1b0
.long 0xe660, 0x22b00, 0x60, 0x1c0, 0xe670, 0x22b10, 0x70, 0x1d0
.long 0xe680, 0x27720, 0x8, 0x160, 0xe690, 0x27730, 0x18, 0x170
.long 0xe6a0, 0x27700, 0x28, 0x180, 0xe6b0, 0x27710, 0x38, 0x190
.long 0xea80, 0x27760, 0x48, 0x1e0, 0xea90, 0x27770, 0x58, 0x1f0
.long 0xeaa0, 0x27740, 0x68, 0x200, 0xeab0, 0x27750, 0x78, 0x210
.long 0xeac0, 0x277a0, 0x80, 0x220, 0xead0, 0x277b0, 0x90, 0x230
.long 0xeae0, 0x27780, 0xa0, 0x240, 0xeaf0, 0x27790, 0xb0, 0x250
.long 0xeb00, 0x27ba0, 0xc0, 0x260, 0xeb10, 0x27bb0, 0xd0, 0x270
.long 0xeb20, 0x27b80, 0xe0, 0x280, 0xeb30, 0x27b90, 0xf0, 0x290
.long 0x13700, 0x27be0, 0x88, 0x2a0, 0x13710, 0x27bf0, 0x98, 0x2b0
.long 0x13720, 0x27bc0, 0xa8, 0x2c0, 0x13730, 0x27bd0, 0xb8, 0x2d0
.long 0x13740, 0x27c20, 0xc8, 0x2e0, 0x13750, 0x27c30, 0xd8, 0x2f0
.long 0x13760, 0x27c00, 0xe8, 0x300, 0x13770, 0x27c10, 0xf8, 0x310
.size M_TAB, 4224
.section .rodata,"a"
.p2align 6
.amdhsa_kernel concat_heads__sliding_block__ssm_conv_h3__prompt_kernel
  .amdhsa_next_free_vgpr 253
  .amdhsa_next_free_sgpr 102
  .amdhsa_accum_offset 256
  .amdhsa_group_segment_fixed_size 0
  .amdhsa_kernarg_size 96
  .amdhsa_user_sgpr_count 2
  .amdhsa_user_sgpr_kernarg_segment_ptr 1
  .amdhsa_system_sgpr_workgroup_id_x 1
.end_amdhsa_kernel
```
